```python
import torch

def _softmax(x, axis=-1):
    return torch.softmax(x, dim=axis)
def _gelu(x):
    return torch.nn.functional.gelu(x, approximate="tanh")
def _silu(x):
    return torch.nn.functional.silu(x)
def _sigmoid(x):
    return torch.sigmoid(x)
def _layernorm(x, axis=-1, eps=1e-5):
    m = x.mean(dim=axis, keepdim=True)
    v = x.var(dim=axis, keepdim=True, unbiased=False)
    return (x - m) / torch.sqrt(v + eps)
def _scatter_add(tgt, idx, src, axis=0):
    return tgt.clone().index_add_(axis, idx, src)
def _segment_sum(src, seg, n):
    out = torch.zeros((n,) + src.shape[1:], dtype=src.dtype)
    return out.index_add_(0, seg, src)
def _pad(x, pw):
    flat = tuple(v for pair in reversed(pw) for v in pair)
    return torch.nn.functional.pad(x, flat)

kernel_name = 'recurrent_scan__sliding_block_cached__glu_gated_swiglu__decode'

def setup_inputs():

    _w = (lambda a: (lambda t: t.to(torch.bfloat16) if t.is_floating_point() else t)(torch.as_tensor(a)))
    def _A_setup():
        B, Sq, D = 2, 1, 576
        Hq, Hkv, Sk, Dh = 32, 16, 32768, 128
        assert Hq % Hkv == 0, (Hq, Hkv)
        return {
            "x": _w((lambda *s: torch.randn(*s, dtype=torch.bfloat16) * 0.05)(B, Sq, D)),
            "k_cache": _w((lambda *s: torch.randn(*s, dtype=torch.bfloat16) * 3.2)(B, Hkv, Sk, Dh)),
            "v_cache": _w((lambda *s: torch.randn(*s, dtype=torch.bfloat16) * 3.2)(B, Hkv, Sk, Dh)),
            "wq": _w((lambda *s: torch.randn(*s, dtype=torch.bfloat16) * 3.2)(D, Hq * Dh) * (D ** -0.5)),
            "wo": _w((lambda *s: torch.randn(*s, dtype=torch.bfloat16) * 3.2)(Hq * Dh, D) * ((Hq * Dh) ** -0.5)),
        }
    _A_in = _A_setup()

    def _B_setup():
        B, S, D, F = 2, 1, 576, 4608
        return {
            "x": _w((lambda *s: torch.randn(*s, dtype=torch.bfloat16) * 0.05)(B, S, D)),
            "w1": _w((lambda *s: torch.randn(*s, dtype=torch.bfloat16) * 0.4)(D, F) * (2.0 / D) ** 0.5),
            "w3": _w((lambda *s: torch.randn(*s, dtype=torch.bfloat16) * 0.4)(D, F) * (2.0 / D) ** 0.5),
            "w2": _w((lambda *s: torch.randn(*s, dtype=torch.bfloat16) * 0.4)(F, D) * (2.0 / F) ** 0.5),
        }
    _B_in = _B_setup()

    return {
        "A_x": _A_in["x"],
        "A_k_cache": _A_in["k_cache"],
        "A_v_cache": _A_in["v_cache"],
        "A_wq": _A_in["wq"],
        "A_wo": _A_in["wo"],
        "B_x": _B_in["x"],
        "B_w1": _B_in["w1"],
        "B_w3": _B_in["w3"],
        "B_w2": _B_in["w2"],
    }

def reference(A_x, A_k_cache, A_v_cache, A_wq, A_wo, B_x, B_w1, B_w3, B_w2):
    def _A_ref(x, k_cache, v_cache, wq, wo):
        B, Sq, D = x.shape
        Hq, Dh = 32, 128
        Hkv, Sk = k_cache.shape[1], k_cache.shape[2]
        W = min(4096, max(256, Sk // 4))
        rep = Hq // Hkv
        q = (lambda x, *d: x.permute(*d))((x @ wq).reshape(B, Sq, Hq, Dh), 0, 2, 1, 3)
        k = (lambda x, n, axis: torch.repeat_interleave(x, n, dim=axis))(k_cache[:, :, Sk - W:, :], rep, axis=1)
        v = (lambda x, n, axis: torch.repeat_interleave(x, n, dim=axis))(v_cache[:, :, Sk - W:, :], rep, axis=1)
        scores = torch.einsum("bhqd,bhkd->bhqk", q, k) * (Dh ** -0.5)
        p = _softmax(scores, axis=-1)
        o = torch.einsum("bhqk,bhkd->bhqd", p, v)
        return (lambda x, *d: x.permute(*d))(o, 0, 2, 1, 3).reshape(B, Sq, Hq * Dh) @ wo

    def _B_ref(x, w1, w3, w2):
        gate = torch.einsum("bsd,df->bsf", x, w1)
        up = torch.einsum("bsd,df->bsf", x, w3)
        h = _silu(gate) * up
        out = torch.einsum("bsf,fd->bsd", h, w2)
        return out

    x = A_x
    xn = _layernorm(x, axis=-1)
    s = _A_ref(xn, A_k_cache, A_v_cache, A_wq, A_wo)
    g = _silu(_B_ref(xn, B_w1, B_w3, B_w2))
    return x + s * g
```

```asm
; @launch grid=(256,1,1) block=(256,1,1) lds=17024
.amdgcn_target "amdgcn-amd-amdhsa--gfx950"
.text
.globl recurrent_scan__sliding_block_cached__glu_gated_swiglu__decode_kernel
.p2align 12
.type recurrent_scan__sliding_block_cached__glu_gated_swiglu__decode_kernel,@function
recurrent_scan__sliding_block_cached__glu_gated_swiglu__decode_kernel:
    s_cmp_ge_u32 s2, 256
    s_cbranch_scc1 L_end
    s_load_dwordx16 s[4:19], s[0:1], 0
    s_load_dwordx8 s[20:27], s[0:1], 64
    v_lshrrev_b32 v15, 6, v0
    v_and_b32 v0, 63, v0
    v_readfirstlane_b32 s3, v15
    v_lshrrev_b32 v1, 4, v0
    v_and_b32 v2, 15, v0
    v_lshlrev_b32 v4, 4, v0
    v_bfe_u32 v16, v0, 2, 2
    v_and_b32 v17, 3, v0
    v_lshlrev_b32 v3, 8, v16
    v_lshl_add_u32 v3, v1, 6, v3
    v_lshl_add_u32 v3, v17, 4, v3
    s_lshr_b32 s66, s2, 3
    s_and_b32 s77, s2, 7
    s_lshr_b32 s75, s66, 4
    s_and_b32 s76, s66, 15
    s_and_b32 s78, s2, 1
    s_lshl_b32 s80, s76, 1
    s_add_u32 s80, s80, s75
    s_lshl_b32 s80, s80, 2
    s_lshr_b32 s67, s77, 1
    s_add_u32 s80, s80, s67
    s_mov_b32 s79, s80
    s_mul_i32 s67, s2, 1237
    s_lshr_b32 s67, s67, 2
    s_and_b32 s67, s67, 127
    s_xor_b32 s67, s67, s3
    s_lshl_b32 s67, s67, 10
    s_lshl_b32 s64, s66, 23
    s_lshl_b32 s68, s77, 17
    s_add_u32 s64, s64, s68
    s_add_u32 s64, s64, 7340032
    s_or_b32 s64, s64, s67
    s_mov_b32 s72, 100000
    s_mov_b32 s73, 1069066811
    s_mov_b32 s74, 1035273459
    s_mov_b32 s85, 4608
    s_mov_b32 s86, 9216
    s_mov_b32 s30, 268435456
    s_mov_b32 s31, 0x20000
    s_mov_b32 s50, 8388608
    s_mov_b32 s51, 0x20000
    s_mov_b32 s54, 2304
    s_mov_b32 s55, 0x20000
    s_sub_u32 s67, s2, 144
    s_cmp_lt_u32 s67, 48
    s_cbranch_scc1 L_light
    s_sub_u32 s67, s2, 48
    s_cmp_lt_u32 s2, 144
    s_cselect_b32 s67, s2, s67
    s_lshr_b32 s89, s67, 1
    s_and_b32 s67, s67, 1
    s_mov_b32 s66, s89
    s_cmp_lt_u32 s66, 32
    s_cbranch_scc1 L_selq
    s_cmp_lt_u32 s66, 68
    s_cbranch_scc1 L_sel1
    s_sub_u32 s66, s66, 68
    s_lshl_b32 s83, s67, 1
    s_add_u32 s83, s83, 4
    s_branch L_selg
L_sel1:
    s_sub_u32 s66, s66, 32
    s_lshl_b32 s83, s67, 1
L_selg:
    s_mov_b32 s38, 5308416
    s_mov_b32 s81, 9216
    s_mov_b32 s84, 0
    s_add_u32 s83, s83, s3
    s_mul_i32 s83, s83, 18432
    s_lshl_b32 s68, s66, 9
    s_add_u32 s83, s83, s68
    s_add_u32 s83, s83, 135168
    s_branch L_seld
L_selq:
    s_mov_b32 s38, 4718592
    s_mov_b32 s81, 8192
    s_mov_b32 s84, 1
    s_lshl_b32 s83, s67, 1
    s_add_u32 s83, s83, s3
    s_lshl_b32 s83, s83, 15
    s_lshl_b32 s68, s66, 10
    s_add_u32 s83, s83, s68
    s_add_u32 s83, s83, 4096
L_seld:
    s_mov_b32 s39, 0x20000
    v_lshrrev_b32 v15, 5, v0
    v_and_b32 v16, 31, v0
    v_mul_u32_u24 v21, 1152, v15
    v_mad_u32_u24 v21, v16, 12, v21
    s_mul_i32 s68, s67, 288
    s_mul_i32 s69, s3, 72
    s_add_u32 s68, s68, s69
    v_lshl_add_u32 v29, v1, 1, s68
    v_mul_lo_u32 v29, v29, s81
    s_lshl_b32 s69, s66, 8
    v_lshl_add_u32 v29, v2, 4, v29
    v_add_u32 v29, s69, v29
    v_lshrrev_b32 v17, 3, v2
    v_lshl_add_u32 v33, v1, 1, s68
    v_lshlrev_b32 v33, 1, v33
    v_mul_u32_u24 v17, 1152, v17
    v_add_u32 v33, v17, v33
    s_mov_b32 s82, 0
    s_mul_i32 s65, s81, 7
    s_waitcnt lgkmcnt(0)
    s_mov_b32 s52, s4
    s_and_b32 s53, s5, 0xffff
    buffer_load_dwordx3 v[26:28], v21, s[52:55], 0 offen offset:0
    buffer_load_dwordx3 v[30:32], v21, s[52:55], 0 offen offset:384
    buffer_load_dwordx3 v[34:36], v21, s[52:55], 0 offen offset:768
    s_cmp_lt_u32 s89, 68
    s_cselect_b32 s36, s16, s18
    s_cselect_b32 s37, s17, s19
    s_cmp_lt_u32 s89, 32
    s_cselect_b32 s36, s10, s36
    s_cselect_b32 s37, s11, s37
    s_and_b32 s37, s37, 0xffff
    buffer_load_dwordx4 v[38:41], v29, s[36:39], s82 offen nt
    s_add_u32 s82, s82, s81
    buffer_load_dwordx4 v[42:45], v29, s[36:39], s82 offen nt
    s_add_u32 s82, s82, s65
    buffer_load_dwordx4 v[46:49], v29, s[36:39], s82 offen nt
    s_add_u32 s82, s82, s81
    buffer_load_dwordx4 v[50:53], v29, s[36:39], s82 offen nt
    s_add_u32 s82, s82, s65
    s_mov_b32 s28, s6
    s_and_b32 s29, s7, 0xffff
    s_mov_b32 s48, s26
    s_and_b32 s49, s27, 0xffff
    s_load_dword s62, s[26:27], 0
    s_cmp_lg_u32 s3, 3
    s_cbranch_scc1 L_nopfh
    s_getpc_b64 s[60:61]
L_pch:
    s_sub_u32 s60, s60, L_pch-recurrent_scan__sliding_block_cached__glu_gated_swiglu__decode_kernel
    s_subb_u32 s61, s61, 0
    s_lshr_b32 s67, s2, 3
    s_and_b32 s67, s67, 15
    s_lshl_b32 s67, s67, 10
    v_add_u32 v15, s67, v4
    v_min_u32 v15, L_codelast-recurrent_scan__sliding_block_cached__glu_gated_swiglu__decode_kernel, v15
    global_load_dwordx4 v[22:25], v15, s[60:61]
L_nopfh:
    buffer_load_dwordx4 v[54:57], v29, s[36:39], s82 offen nt
    s_add_u32 s82, s82, s81
    buffer_load_dwordx4 v[58:61], v29, s[36:39], s82 offen nt
    s_add_u32 s82, s82, s65
    buffer_load_dwordx4 v[62:65], v29, s[36:39], s82 offen nt
    s_add_u32 s82, s82, s81
    buffer_load_dwordx4 v[66:69], v29, s[36:39], s82 offen nt
    s_add_u32 s82, s82, s65
    buffer_load_dwordx4 v[70:73], v29, s[36:39], s82 offen nt
    s_add_u32 s82, s82, s81
    buffer_load_dwordx4 v[74:77], v29, s[36:39], s82 offen nt
    s_add_u32 s82, s82, s65
    buffer_load_dwordx4 v[78:81], v29, s[36:39], s82 offen nt
    s_add_u32 s82, s82, s81
    buffer_load_dwordx4 v[82:85], v29, s[36:39], s82 offen nt
    s_add_u32 s82, s82, s65
    v_mov_b32 v5, 0xffffff00
    v_lshrrev_b32 v15, 1, v1
    v_and_b32 v16, 1, v1
    v_lshl_add_u32 v16, v2, 1, v16
    v_lshlrev_b32 v16, 4, v16
    v_lshl_add_u32 v6, v15, 9, v16
    v_and_b32 v15, 1, v0
    v_bfe_u32 v16, v0, 1, 2
    v_cmp_eq_u32 vcc, 1, v15
    v_mov_b32 v17, 202113280
    v_mov_b32 v18, 16780300
    v_cndmask_b32 v19, v17, v18, vcc
    v_mov_b32 v17, 202113794
    v_mov_b32 v18, 50465804
    v_cndmask_b32 v20, v17, v18, vcc
    v_mov_b32 v17, 0x0c0c0c0c
    v_cmp_eq_u32 vcc, 0, v16
    s_nop 1
    v_cndmask_b32 v7, v17, v19, vcc
    v_cndmask_b32 v11, v17, v20, vcc
    v_cmp_eq_u32 vcc, 1, v16
    s_nop 1
    v_cndmask_b32 v8, v17, v19, vcc
    v_cndmask_b32 v12, v17, v20, vcc
    v_cmp_eq_u32 vcc, 2, v16
    s_nop 1
    v_cndmask_b32 v9, v17, v19, vcc
    v_cndmask_b32 v13, v17, v20, vcc
    v_cmp_eq_u32 vcc, 3, v16
    s_nop 1
    v_cndmask_b32 v10, v17, v19, vcc
    v_cndmask_b32 v14, v17, v20, vcc
    s_waitcnt vmcnt(12)
    v_lshlrev_b32 v37, 16, v26
    v_and_b32 v110, 0xffff0000, v26
    v_lshlrev_b32 v111, 16, v27
    v_and_b32 v112, 0xffff0000, v27
    v_lshlrev_b32 v113, 16, v28
    v_and_b32 v114, 0xffff0000, v28
    v_lshlrev_b32 v115, 16, v30
    v_and_b32 v116, 0xffff0000, v30
    v_lshlrev_b32 v117, 16, v31
    v_and_b32 v118, 0xffff0000, v31
    v_lshlrev_b32 v119, 16, v32
    v_and_b32 v120, 0xffff0000, v32
    v_lshlrev_b32 v121, 16, v34
    v_and_b32 v122, 0xffff0000, v34
    v_lshlrev_b32 v123, 16, v35
    v_and_b32 v124, 0xffff0000, v35
    v_lshlrev_b32 v125, 16, v36
    v_and_b32 v126, 0xffff0000, v36
    v_add_f32 v15, v37, v110
    v_add_f32 v19, v111, v112
    v_add_f32 v15, v15, v113
    v_add_f32 v19, v19, v114
    v_add_f32 v15, v15, v115
    v_add_f32 v19, v19, v116
    v_add_f32 v15, v15, v117
    v_add_f32 v19, v19, v118
    v_add_f32 v15, v15, v119
    v_add_f32 v19, v19, v120
    v_add_f32 v15, v15, v121
    v_add_f32 v19, v19, v122
    v_add_f32 v15, v15, v123
    v_add_f32 v19, v19, v124
    v_add_f32 v15, v15, v125
    v_add_f32 v19, v19, v126
    v_add_f32 v15, v15, v19
    s_nop 1
    v_add_f32_dpp v15, v15, v15 quad_perm:[1,0,3,2] row_mask:0xf bank_mask:0xf
    s_nop 1
    v_add_f32_dpp v15, v15, v15 quad_perm:[2,3,0,1] row_mask:0xf bank_mask:0xf
    s_nop 1
    v_add_f32_dpp v15, v15, v15 row_half_mirror row_mask:0xf bank_mask:0xf
    s_nop 1
    v_add_f32_dpp v15, v15, v15 row_mirror row_mask:0xf bank_mask:0xf
    v_mov_b32 v16, v15
    s_nop 1
    v_permlane16_swap_b32 v15, v16
    v_add_f32 v15, v15, v16
    v_mul_f32 v17, 987991609, v15
    v_mov_b32 v16, 1141899264
    v_fma_f32 v16, -v17, v16, v15
    v_mul_f32 v16, 987991609, v16
    v_add_f32 v17, v17, v16
    v_cvt_pk_bf16_f32 v18, 0, v17
    v_mov_b32 v15, 0
    v_mov_b32 v19, 0
    v_sub_f32 v20, v37, v17
    v_fmac_f32 v15, v20, v20
    v_sub_f32 v20, v110, v17
    v_fmac_f32 v19, v20, v20
    v_sub_f32 v20, v111, v17
    v_fmac_f32 v15, v20, v20
    v_sub_f32 v20, v112, v17
    v_fmac_f32 v19, v20, v20
    v_sub_f32 v20, v113, v17
    v_fmac_f32 v15, v20, v20
    v_sub_f32 v20, v114, v17
    v_fmac_f32 v19, v20, v20
    v_sub_f32 v20, v115, v17
    v_fmac_f32 v15, v20, v20
    v_sub_f32 v20, v116, v17
    v_fmac_f32 v19, v20, v20
    v_sub_f32 v20, v117, v17
    v_fmac_f32 v15, v20, v20
    v_sub_f32 v20, v118, v17
    v_fmac_f32 v19, v20, v20
    v_sub_f32 v20, v119, v17
    v_fmac_f32 v15, v20, v20
    v_sub_f32 v20, v120, v17
    v_fmac_f32 v19, v20, v20
    v_sub_f32 v20, v121, v17
    v_fmac_f32 v15, v20, v20
    v_sub_f32 v20, v122, v17
    v_fmac_f32 v19, v20, v20
    v_sub_f32 v20, v123, v17
    v_fmac_f32 v15, v20, v20
    v_sub_f32 v20, v124, v17
    v_fmac_f32 v19, v20, v20
    v_sub_f32 v20, v125, v17
    v_fmac_f32 v15, v20, v20
    v_sub_f32 v20, v126, v17
    v_fmac_f32 v19, v20, v20
    v_add_f32 v15, v15, v19
    s_nop 1
    v_add_f32_dpp v15, v15, v15 quad_perm:[1,0,3,2] row_mask:0xf bank_mask:0xf
    s_nop 1
    v_add_f32_dpp v15, v15, v15 quad_perm:[2,3,0,1] row_mask:0xf bank_mask:0xf
    s_nop 1
    v_add_f32_dpp v15, v15, v15 row_half_mirror row_mask:0xf bank_mask:0xf
    s_nop 1
    v_add_f32_dpp v15, v15, v15 row_mirror row_mask:0xf bank_mask:0xf
    v_mov_b32 v16, v15
    s_nop 1
    v_permlane16_swap_b32 v15, v16
    v_add_f32 v15, v15, v16
    v_mul_f32 v17, 987991609, v15
    v_mov_b32 v16, 1141899264
    v_fma_f32 v16, -v17, v16, v15
    v_mul_f32 v16, 987991609, v16
    v_add_f32 v17, v17, v16
    v_cvt_pk_bf16_f32 v17, 0, v17
    v_add_f32 v17, 925353388, v17
    v_cvt_pk_bf16_f32 v17, 0, v17
    v_sqrt_f32 v17, v17
    s_nop 0
    v_cvt_pk_bf16_f32 v17, 0, v17
    v_rcp_f32 v15, v17
    v_sub_f32 v37, v37, v18
    v_cvt_pk_bf16_f32 v37, 0, v37
    v_mul_f32 v19, v37, v15
    v_fma_f32 v37, -v19, v17, v37
    v_fma_f32 v37, v37, v15, v19
    v_sub_f32 v110, v110, v18
    v_cvt_pk_bf16_f32 v110, 0, v110
    v_mul_f32 v19, v110, v15
    v_fma_f32 v110, -v19, v17, v110
    v_fma_f32 v110, v110, v15, v19
    v_cvt_pk_bf16_f32 v37, v37, v110
    ds_write_b32 v21, v37 offset:0
    v_sub_f32 v111, v111, v18
    v_cvt_pk_bf16_f32 v111, 0, v111
    v_mul_f32 v19, v111, v15
    v_fma_f32 v111, -v19, v17, v111
    v_fma_f32 v111, v111, v15, v19
    v_sub_f32 v112, v112, v18
    v_cvt_pk_bf16_f32 v112, 0, v112
    v_mul_f32 v19, v112, v15
    v_fma_f32 v112, -v19, v17, v112
    v_fma_f32 v112, v112, v15, v19
    v_cvt_pk_bf16_f32 v111, v111, v112
    ds_write_b32 v21, v111 offset:4
    v_sub_f32 v113, v113, v18
    v_cvt_pk_bf16_f32 v113, 0, v113
    v_mul_f32 v19, v113, v15
    v_fma_f32 v113, -v19, v17, v113
    v_fma_f32 v113, v113, v15, v19
    v_sub_f32 v114, v114, v18
    v_cvt_pk_bf16_f32 v114, 0, v114
    v_mul_f32 v19, v114, v15
    v_fma_f32 v114, -v19, v17, v114
    v_fma_f32 v114, v114, v15, v19
    v_cvt_pk_bf16_f32 v113, v113, v114
    ds_write_b32 v21, v113 offset:8
    v_sub_f32 v115, v115, v18
    v_cvt_pk_bf16_f32 v115, 0, v115
    v_mul_f32 v19, v115, v15
    v_fma_f32 v115, -v19, v17, v115
    v_fma_f32 v115, v115, v15, v19
    v_sub_f32 v116, v116, v18
    v_cvt_pk_bf16_f32 v116, 0, v116
    v_mul_f32 v19, v116, v15
    v_fma_f32 v116, -v19, v17, v116
    v_fma_f32 v116, v116, v15, v19
    v_cvt_pk_bf16_f32 v115, v115, v116
    ds_write_b32 v21, v115 offset:384
    v_sub_f32 v117, v117, v18
    v_cvt_pk_bf16_f32 v117, 0, v117
    v_mul_f32 v19, v117, v15
    v_fma_f32 v117, -v19, v17, v117
    v_fma_f32 v117, v117, v15, v19
    v_sub_f32 v118, v118, v18
    v_cvt_pk_bf16_f32 v118, 0, v118
    v_mul_f32 v19, v118, v15
    v_fma_f32 v118, -v19, v17, v118
    v_fma_f32 v118, v118, v15, v19
    v_cvt_pk_bf16_f32 v117, v117, v118
    ds_write_b32 v21, v117 offset:388
    v_sub_f32 v119, v119, v18
    v_cvt_pk_bf16_f32 v119, 0, v119
    v_mul_f32 v19, v119, v15
    v_fma_f32 v119, -v19, v17, v119
    v_fma_f32 v119, v119, v15, v19
    v_sub_f32 v120, v120, v18
    v_cvt_pk_bf16_f32 v120, 0, v120
    v_mul_f32 v19, v120, v15
    v_fma_f32 v120, -v19, v17, v120
    v_fma_f32 v120, v120, v15, v19
    v_cvt_pk_bf16_f32 v119, v119, v120
    ds_write_b32 v21, v119 offset:392
    v_sub_f32 v121, v121, v18
    v_cvt_pk_bf16_f32 v121, 0, v121
    v_mul_f32 v19, v121, v15
    v_fma_f32 v121, -v19, v17, v121
    v_fma_f32 v121, v121, v15, v19
    v_sub_f32 v122, v122, v18
    v_cvt_pk_bf16_f32 v122, 0, v122
    v_mul_f32 v19, v122, v15
    v_fma_f32 v122, -v19, v17, v122
    v_fma_f32 v122, v122, v15, v19
    v_cvt_pk_bf16_f32 v121, v121, v122
    ds_write_b32 v21, v121 offset:768
    v_sub_f32 v123, v123, v18
    v_cvt_pk_bf16_f32 v123, 0, v123
    v_mul_f32 v19, v123, v15
    v_fma_f32 v123, -v19, v17, v123
    v_fma_f32 v123, v123, v15, v19
    v_sub_f32 v124, v124, v18
    v_cvt_pk_bf16_f32 v124, 0, v124
    v_mul_f32 v19, v124, v15
    v_fma_f32 v124, -v19, v17, v124
    v_fma_f32 v124, v124, v15, v19
    v_cvt_pk_bf16_f32 v123, v123, v124
    ds_write_b32 v21, v123 offset:772
    v_sub_f32 v125, v125, v18
    v_cvt_pk_bf16_f32 v125, 0, v125
    v_mul_f32 v19, v125, v15
    v_fma_f32 v125, -v19, v17, v125
    v_fma_f32 v125, v125, v15, v19
    v_sub_f32 v126, v126, v18
    v_cvt_pk_bf16_f32 v126, 0, v126
    v_mul_f32 v19, v126, v15
    v_fma_f32 v126, -v19, v17, v126
    v_fma_f32 v126, v126, v15, v19
    v_cvt_pk_bf16_f32 v125, v125, v126
    ds_write_b32 v21, v125 offset:776
    s_waitcnt lgkmcnt(0)
    ds_read_b32 v37, v33 offset:0
    ds_read_b32 v110, v33 offset:16
    ds_read_b32 v111, v33 offset:32
    ds_read_b32 v112, v33 offset:48
    ds_read_b32 v113, v33 offset:64
    ds_read_b32 v114, v33 offset:80
    ds_read_b32 v115, v33 offset:96
    ds_read_b32 v116, v33 offset:112
    ds_read_b32 v117, v33 offset:128
    s_waitcnt lgkmcnt(0)
    s_add_u32 s62, s62, 1
    s_and_b32 s63, s62, 255
    v_perm_b32 v128, v37, v37, v7
    v_perm_b32 v129, v37, v37, v8
    v_perm_b32 v130, v37, v37, v9
    v_perm_b32 v131, v37, v37, v10
    s_waitcnt vmcnt(11)
    s_nop 0
    v_mfma_f32_16x16x32_bf16 v[136:139], v[128:131], v[38:41], 0
    buffer_load_dwordx4 v[86:89], v29, s[36:39], s82 offen nt
    s_add_u32 s82, s82, s81
    v_perm_b32 v132, v37, v37, v11
    v_perm_b32 v133, v37, v37, v12
    v_perm_b32 v134, v37, v37, v13
    v_perm_b32 v135, v37, v37, v14
    s_waitcnt vmcnt(11)
    s_nop 0
    v_mfma_f32_16x16x32_bf16 v[136:139], v[132:135], v[42:45], v[136:139]
    buffer_load_dwordx4 v[90:93], v29, s[36:39], s82 offen nt
    s_add_u32 s82, s82, s65
    v_perm_b32 v128, v110, v110, v7
    v_perm_b32 v129, v110, v110, v8
    v_perm_b32 v130, v110, v110, v9
    v_perm_b32 v131, v110, v110, v10
    s_waitcnt vmcnt(11)
    s_nop 0
    v_mfma_f32_16x16x32_bf16 v[136:139], v[128:131], v[46:49], v[136:139]
    buffer_load_dwordx4 v[94:97], v29, s[36:39], s82 offen nt
    s_add_u32 s82, s82, s81
    v_perm_b32 v132, v110, v110, v11
    v_perm_b32 v133, v110, v110, v12
    v_perm_b32 v134, v110, v110, v13
    v_perm_b32 v135, v110, v110, v14
    s_waitcnt vmcnt(11)
    s_nop 0
    v_mfma_f32_16x16x32_bf16 v[136:139], v[132:135], v[50:53], v[136:139]
    buffer_load_dwordx4 v[98:101], v29, s[36:39], s82 offen nt
    s_add_u32 s82, s82, s65
    v_perm_b32 v128, v111, v111, v7
    v_perm_b32 v129, v111, v111, v8
    v_perm_b32 v130, v111, v111, v9
    v_perm_b32 v131, v111, v111, v10
    s_waitcnt vmcnt(11)
    s_nop 0
    v_mfma_f32_16x16x32_bf16 v[136:139], v[128:131], v[54:57], v[136:139]
    buffer_load_dwordx4 v[102:105], v29, s[36:39], s82 offen nt
    s_add_u32 s82, s82, s81
    v_perm_b32 v132, v111, v111, v11
    v_perm_b32 v133, v111, v111, v12
    v_perm_b32 v134, v111, v111, v13
    v_perm_b32 v135, v111, v111, v14
    s_waitcnt vmcnt(11)
    s_nop 0
    v_mfma_f32_16x16x32_bf16 v[136:139], v[132:135], v[58:61], v[136:139]
    buffer_load_dwordx4 v[106:109], v29, s[36:39], s82 offen nt
    v_perm_b32 v128, v112, v112, v7
    v_perm_b32 v129, v112, v112, v8
    v_perm_b32 v130, v112, v112, v9
    v_perm_b32 v131, v112, v112, v10
    s_waitcnt vmcnt(11)
    s_nop 0
    v_mfma_f32_16x16x32_bf16 v[136:139], v[128:131], v[62:65], v[136:139]
    s_xor_b32 s66, s64, 0
    buffer_load_dwordx4 a[0:3], v3, s[28:31], s66 offen nt
    v_perm_b32 v132, v112, v112, v11
    v_perm_b32 v133, v112, v112, v12
    v_perm_b32 v134, v112, v112, v13
    v_perm_b32 v135, v112, v112, v14
    s_waitcnt vmcnt(11)
    s_nop 0
    v_mfma_f32_16x16x32_bf16 v[136:139], v[132:135], v[66:69], v[136:139]
    s_xor_b32 s66, s64, 4096
    buffer_load_dwordx4 a[4:7], v3, s[28:31], s66 offen nt
    v_perm_b32 v128, v113, v113, v7
    v_perm_b32 v129, v113, v113, v8
    v_perm_b32 v130, v113, v113, v9
    v_perm_b32 v131, v113, v113, v10
    s_waitcnt vmcnt(11)
    s_nop 0
    v_mfma_f32_16x16x32_bf16 v[136:139], v[128:131], v[70:73], v[136:139]
    s_xor_b32 s66, s64, 8192
    buffer_load_dwordx4 a[8:11], v3, s[28:31], s66 offen nt
    v_perm_b32 v132, v113, v113, v11
    v_perm_b32 v133, v113, v113, v12
    v_perm_b32 v134, v113, v113, v13
    v_perm_b32 v135, v113, v113, v14
    s_waitcnt vmcnt(11)
    s_nop 0
    v_mfma_f32_16x16x32_bf16 v[136:139], v[132:135], v[74:77], v[136:139]
    s_xor_b32 s66, s64, 12288
    buffer_load_dwordx4 a[12:15], v3, s[28:31], s66 offen nt
    v_perm_b32 v128, v114, v114, v7
    v_perm_b32 v129, v114, v114, v8
    v_perm_b32 v130, v114, v114, v9
    v_perm_b32 v131, v114, v114, v10
    s_waitcnt vmcnt(11)
    s_nop 0
    v_mfma_f32_16x16x32_bf16 v[136:139], v[128:131], v[78:81], v[136:139]
    s_xor_b32 s66, s64, 16384
    buffer_load_dwordx4 a[16:19], v3, s[28:31], s66 offen nt
    v_perm_b32 v132, v114, v114, v11
    v_perm_b32 v133, v114, v114, v12
    v_perm_b32 v134, v114, v114, v13
    v_perm_b32 v135, v114, v114, v14
    s_waitcnt vmcnt(11)
    s_nop 0
    v_mfma_f32_16x16x32_bf16 v[136:139], v[132:135], v[82:85], v[136:139]
    s_xor_b32 s66, s64, 20480
    buffer_load_dwordx4 a[20:23], v3, s[28:31], s66 offen nt
    v_perm_b32 v128, v115, v115, v7
    v_perm_b32 v129, v115, v115, v8
    v_perm_b32 v130, v115, v115, v9
    v_perm_b32 v131, v115, v115, v10
    s_waitcnt vmcnt(11)
    s_nop 0
    v_mfma_f32_16x16x32_bf16 v[136:139], v[128:131], v[86:89], v[136:139]
    s_xor_b32 s66, s64, 24576
    buffer_load_dwordx4 a[24:27], v3, s[28:31], s66 offen nt
    v_perm_b32 v132, v115, v115, v11
    v_perm_b32 v133, v115, v115, v12
    v_perm_b32 v134, v115, v115, v13
    v_perm_b32 v135, v115, v115, v14
    s_waitcnt vmcnt(11)
    s_nop 0
    v_mfma_f32_16x16x32_bf16 v[136:139], v[132:135], v[90:93], v[136:139]
    s_xor_b32 s66, s64, 28672
    buffer_load_dwordx4 a[28:31], v3, s[28:31], s66 offen nt
    v_perm_b32 v128, v116, v116, v7
    v_perm_b32 v129, v116, v116, v8
    v_perm_b32 v130, v116, v116, v9
    v_perm_b32 v131, v116, v116, v10
    s_waitcnt vmcnt(11)
    s_nop 0
    v_mfma_f32_16x16x32_bf16 v[136:139], v[128:131], v[94:97], v[136:139]
    s_xor_b32 s66, s64, 32768
    buffer_load_dwordx4 a[32:35], v3, s[28:31], s66 offen nt
    v_perm_b32 v132, v116, v116, v11
    v_perm_b32 v133, v116, v116, v12
    v_perm_b32 v134, v116, v116, v13
    v_perm_b32 v135, v116, v116, v14
    s_waitcnt vmcnt(11)
    s_nop 0
    v_mfma_f32_16x16x32_bf16 v[136:139], v[132:135], v[98:101], v[136:139]
    s_xor_b32 s66, s64, 36864
    buffer_load_dwordx4 a[36:39], v3, s[28:31], s66 offen nt
    v_perm_b32 v128, v117, v117, v7
    v_perm_b32 v129, v117, v117, v8
    v_perm_b32 v130, v117, v117, v9
    v_perm_b32 v131, v117, v117, v10
    s_waitcnt vmcnt(11)
    s_nop 0
    v_mfma_f32_16x16x32_bf16 v[136:139], v[128:131], v[102:105], v[136:139]
    s_xor_b32 s66, s64, 40960
    buffer_load_dwordx4 a[40:43], v3, s[28:31], s66 offen nt
    v_perm_b32 v132, v117, v117, v11
    v_perm_b32 v133, v117, v117, v12
    v_perm_b32 v134, v117, v117, v13
    v_perm_b32 v135, v117, v117, v14
    s_waitcnt vmcnt(11)
    s_nop 0
    v_mfma_f32_16x16x32_bf16 v[136:139], v[132:135], v[106:109], v[136:139]
    s_xor_b32 s66, s64, 45056
    buffer_load_dwordx4 a[44:47], v3, s[28:31], s66 offen nt
    s_lshl_b32 s67, s3, 10
    v_add_u32 v15, s67, v6
    s_nop 3
    ds_write_b128 v15, v[136:139] offset:2560
    s_waitcnt lgkmcnt(0)
    s_barrier
    s_cmp_ge_u32 s3, 2
    s_cbranch_scc1 L_join
    s_lshl_b32 s67, s3, 9
    v_lshl_add_u32 v15, v0, 3, s67
    ds_read_b64 v[38:39], v15 offset:2560
    ds_read_b64 v[42:43], v15 offset:3584
    ds_read_b64 v[46:47], v15 offset:4608
    ds_read_b64 v[50:51], v15 offset:5632
    s_waitcnt lgkmcnt(0)
    v_add_f32 v38, v38, v42
    v_add_f32 v46, v46, v50
    v_add_f32 v38, v38, v46
    v_add_f32 v39, v39, v43
    v_add_f32 v47, v47, v51
    v_add_f32 v39, v39, v47
    s_cmp_eq_u32 s84, 0
    s_cbranch_scc1 L_pubg
    v_mov_b32 v42, v38
    v_mov_b32 v43, s62
    v_mov_b32 v44, v39
    v_mov_b32 v45, s62
    buffer_store_dwordx4 v[42:45], v4, s[48:51], s83 offen sc1
    s_branch L_join
L_pubg:
    v_and_or_b32 v38, v38, v5, s63
    v_and_or_b32 v39, v39, v5, s63
    v_lshlrev_b32 v15, 3, v0
    buffer_store_dwordx2 v[38:39], v15, s[48:51], s83 offen sc1
    s_branch L_join
L_light:
    s_waitcnt lgkmcnt(0)
    s_mov_b32 s28, s6
    s_and_b32 s29, s7, 0xffff
    s_mov_b32 s48, s26
    s_and_b32 s49, s27, 0xffff
    s_load_dword s62, s[26:27], 0
    s_cmp_lg_u32 s3, 3
    s_cbranch_scc1 L_nopfs
    s_getpc_b64 s[60:61]
L_pcs:
    s_sub_u32 s60, s60, L_pcs-recurrent_scan__sliding_block_cached__glu_gated_swiglu__decode_kernel
    s_subb_u32 s61, s61, 0
    s_lshr_b32 s67, s2, 3
    s_and_b32 s67, s67, 15
    s_lshl_b32 s67, s67, 10
    v_add_u32 v15, s67, v4
    v_min_u32 v15, L_codelast-recurrent_scan__sliding_block_cached__glu_gated_swiglu__decode_kernel, v15
    global_load_dwordx4 v[22:25], v15, s[60:61]
L_nopfs:
    s_xor_b32 s66, s64, 0
    buffer_load_dwordx4 a[0:3], v3, s[28:31], s66 offen nt
    s_xor_b32 s66, s64, 4096
    buffer_load_dwordx4 a[4:7], v3, s[28:31], s66 offen nt
    s_xor_b32 s66, s64, 8192
    buffer_load_dwordx4 a[8:11], v3, s[28:31], s66 offen nt
    s_xor_b32 s66, s64, 12288
    buffer_load_dwordx4 a[12:15], v3, s[28:31], s66 offen nt
    s_xor_b32 s66, s64, 16384
    buffer_load_dwordx4 a[16:19], v3, s[28:31], s66 offen nt
    s_xor_b32 s66, s64, 20480
    buffer_load_dwordx4 a[20:23], v3, s[28:31], s66 offen nt
    s_xor_b32 s66, s64, 24576
    buffer_load_dwordx4 a[24:27], v3, s[28:31], s66 offen nt
    s_xor_b32 s66, s64, 28672
    buffer_load_dwordx4 a[28:31], v3, s[28:31], s66 offen nt
    s_xor_b32 s66, s64, 32768
    buffer_load_dwordx4 a[32:35], v3, s[28:31], s66 offen nt
    s_xor_b32 s66, s64, 36864
    buffer_load_dwordx4 a[36:39], v3, s[28:31], s66 offen nt
    s_xor_b32 s66, s64, 40960
    buffer_load_dwordx4 a[40:43], v3, s[28:31], s66 offen nt
    s_xor_b32 s66, s64, 45056
    buffer_load_dwordx4 a[44:47], v3, s[28:31], s66 offen nt
    v_mov_b32 v5, 0xffffff00
    v_lshrrev_b32 v15, 1, v1
    v_and_b32 v16, 1, v1
    v_lshl_add_u32 v16, v2, 1, v16
    v_lshlrev_b32 v16, 4, v16
    v_lshl_add_u32 v6, v15, 9, v16
    v_and_b32 v15, 1, v0
    v_bfe_u32 v16, v0, 1, 2
    v_cmp_eq_u32 vcc, 1, v15
    v_mov_b32 v17, 202113280
    v_mov_b32 v18, 16780300
    v_cndmask_b32 v19, v17, v18, vcc
    v_mov_b32 v17, 202113794
    v_mov_b32 v18, 50465804
    v_cndmask_b32 v20, v17, v18, vcc
    v_mov_b32 v17, 0x0c0c0c0c
    v_cmp_eq_u32 vcc, 0, v16
    s_nop 1
    v_cndmask_b32 v7, v17, v19, vcc
    v_cndmask_b32 v11, v17, v20, vcc
    v_cmp_eq_u32 vcc, 1, v16
    s_nop 1
    v_cndmask_b32 v8, v17, v19, vcc
    v_cndmask_b32 v12, v17, v20, vcc
    v_cmp_eq_u32 vcc, 2, v16
    s_nop 1
    v_cndmask_b32 v9, v17, v19, vcc
    v_cndmask_b32 v13, v17, v20, vcc
    v_cmp_eq_u32 vcc, 3, v16
    s_nop 1
    v_cndmask_b32 v10, v17, v19, vcc
    v_cndmask_b32 v14, v17, v20, vcc
    s_waitcnt lgkmcnt(0)
    s_add_u32 s62, s62, 1
    s_and_b32 s63, s62, 255
L_join:
    s_mov_b32 s32, s8
    s_and_b32 s33, s9, 0xffff
    s_mov_b32 s34, 268435456
    s_mov_b32 s35, 0x20000
    s_mov_b32 s40, s12
    s_and_b32 s41, s13, 0xffff
    s_mov_b32 s42, 4718592
    s_mov_b32 s43, 0x20000
    s_mov_b32 s44, s20
    s_and_b32 s45, s21, 0xffff
    s_mov_b32 s46, 5308416
    s_mov_b32 s47, 0x20000
    v_mov_b32 v35, 2146435072
    v_mov_b32 v34, 0
    s_mov_b32 s52, s4
    s_and_b32 s53, s5, 0xffff
    s_mov_b32 s54, 2304
    s_mov_b32 s55, 0x20000
    s_mov_b32 s56, s22
    s_and_b32 s57, s23, 0xffff
    s_mov_b32 s58, 2304
    s_mov_b32 s59, 0x20000
    s_sub_u32 s89, s2, 156
    s_cmp_ge_u32 s89, 36
    s_cbranch_scc1 L_notouch
    s_lshl_b32 s67, s89, 6
    v_lshl_add_u32 v16, v0, 1, s67
    v_cmp_gt_u32 vcc, 32, v0
    v_mov_b32 v15, 2146435072
    s_nop 0
    v_cndmask_b32 v35, v15, v16, vcc
    buffer_load_ushort v34, v35, s[52:55], 0 offen
    s_lshl_b32 s67, s89, 14
    s_lshl_b32 s68, s3, 12
    s_add_u32 s67, s67, s68
    s_add_u32 s67, s67, 548864
    v_and_b32 v15, 31, v0
    v_lshlrev_b32 v15, 7, v15
    v_lshrrev_b32 v16, 5, v0
    v_mul_u32_u24 v16, 589824, v16
    v_add_u32 v15, v15, v16
    buffer_load_dword v22, v15, s[48:51], s67 offen sc1
L_notouch:
    s_mul_i32 s87, s3, 12
    s_mul_i32 s67, s78, 36
    s_add_u32 s87, s87, s67
    s_sub_u32 s87, s87, 12
    s_cmp_eq_u32 s3, 0
    s_cselect_b32 s88, 0, 12
    v_add_u32 v39, s87, v2
    v_cmp_gt_u32 s[70:71], s88, v2
    v_lshlrev_b32 v15, 4, v39
    s_mul_i32 s67, s79, 36
    v_mul_u32_u24 v16, 9, v1
    v_add_u32 v16, s67, v16
    v_mul_u32_u24 v16, 1152, v16
    v_add_u32 v36, v15, v16
    s_lshl_b32 s67, s80, 5
    v_lshl_add_u32 v16, v1, 3, s67
    v_mul_u32_u24 v16, 1152, v16
    v_add_u32 v37, v15, v16
    s_mul_i32 s67, s78, 9
    s_mul_i32 s68, s3, 3
    s_add_u32 s67, s67, s68
    s_sub_u32 s67, s67, 3
    v_lshrrev_b32 v15, 1, v1
    v_mul_u32_u24 v15, 18, v15
    v_lshrrev_b32 v16, 2, v2
    v_add3_u32 v15, v15, v16, s67
    v_lshlrev_b32 v15, 14, v15
    v_and_b32 v17, 1, v1
    v_lshl_add_u32 v15, v17, 6, v15
    v_and_b32 v17, 3, v2
    v_lshl_add_u32 v38, v17, 4, v15
    v_cmp_gt_u32 vcc, 3, v16
    v_mov_b32 v15, 2146435072
    s_nop 0
    v_cndmask_b32 v38, v15, v38, vcc
    v_mov_b32 v15, 2146435072
    v_cndmask_b32 v36, v15, v36, s[70:71]
    v_cndmask_b32 v37, v15, v37, s[70:71]
    s_waitcnt vmcnt(7)
    s_xor_b32 s66, s64, 49152
    buffer_load_dwordx4 a[48:51], v3, s[28:31], s66 offen nt
    s_waitcnt vmcnt(7)
    s_xor_b32 s66, s64, 53248
    buffer_load_dwordx4 a[52:55], v3, s[28:31], s66 offen nt
    s_waitcnt vmcnt(7)
    s_xor_b32 s66, s64, 57344
    buffer_load_dwordx4 a[56:59], v3, s[28:31], s66 offen nt
    s_waitcnt vmcnt(7)
    s_xor_b32 s66, s64, 61440
    buffer_load_dwordx4 a[60:63], v3, s[28:31], s66 offen nt
    s_waitcnt vmcnt(7)
    s_xor_b32 s66, s64, 65536
    buffer_load_dwordx4 a[64:67], v3, s[28:31], s66 offen nt
    s_waitcnt vmcnt(7)
    s_xor_b32 s66, s64, 69632
    buffer_load_dwordx4 a[68:71], v3, s[28:31], s66 offen nt
    s_waitcnt vmcnt(7)
    s_xor_b32 s66, s64, 73728
    buffer_load_dwordx4 a[72:75], v3, s[28:31], s66 offen nt
    s_waitcnt vmcnt(7)
    s_xor_b32 s66, s64, 77824
    buffer_load_dwordx4 a[76:79], v3, s[28:31], s66 offen nt
    s_waitcnt vmcnt(7)
    s_xor_b32 s66, s64, 81920
    buffer_load_dwordx4 a[80:83], v3, s[28:31], s66 offen nt
    s_waitcnt vmcnt(7)
    s_xor_b32 s66, s64, 86016
    buffer_load_dwordx4 a[84:87], v3, s[28:31], s66 offen nt
    s_waitcnt vmcnt(7)
    s_xor_b32 s66, s64, 90112
    buffer_load_dwordx4 a[88:91], v3, s[28:31], s66 offen nt
    s_waitcnt vmcnt(7)
    s_xor_b32 s66, s64, 94208
    buffer_load_dwordx4 a[92:95], v3, s[28:31], s66 offen nt
    s_waitcnt vmcnt(7)
    s_xor_b32 s66, s64, 98304
    buffer_load_dwordx4 a[96:99], v3, s[28:31], s66 offen nt
    s_waitcnt vmcnt(7)
    s_xor_b32 s66, s64, 102400
    buffer_load_dwordx4 a[100:103], v3, s[28:31], s66 offen nt
    s_waitcnt vmcnt(7)
    s_xor_b32 s66, s64, 106496
    buffer_load_dwordx4 a[104:107], v3, s[28:31], s66 offen nt
    s_waitcnt vmcnt(7)
    s_xor_b32 s66, s64, 110592
    buffer_load_dwordx4 a[108:111], v3, s[28:31], s66 offen nt
    s_waitcnt vmcnt(7)
    s_xor_b32 s66, s64, 114688
    buffer_load_dwordx4 a[112:115], v3, s[28:31], s66 offen nt
    s_waitcnt vmcnt(7)
    s_xor_b32 s66, s64, 118784
    buffer_load_dwordx4 a[116:119], v3, s[28:31], s66 offen nt
    s_waitcnt vmcnt(7)
    s_xor_b32 s66, s64, 122880
    buffer_load_dwordx4 a[120:123], v3, s[28:31], s66 offen nt
    s_waitcnt vmcnt(7)
    s_xor_b32 s66, s64, 126976
    buffer_load_dwordx4 a[124:127], v3, s[28:31], s66 offen nt
    v_lshlrev_b32 v39, 3, v0
    s_lshl_b32 s68, s75, 15
    s_lshl_b32 s67, s76, 11
    s_add_u32 s68, s68, s67
    s_lshl_b32 s67, s3, 9
    s_add_u32 s68, s68, s67
    s_add_u32 s68, s68, 4096
    s_add_u32 s69, s68, 65536
    s_waitcnt vmcnt(7)
    buffer_load_dwordx2 v[40:41], v39, s[48:51], s68 offen sc1
    buffer_load_dwordx2 v[42:43], v39, s[48:51], s69 offen sc1
    v_lshrrev_b32 v15, 5, v0
    v_and_b32 v16, 31, v0
    v_mul_u32_u24 v21, 18432, v15
    v_lshl_add_u32 v21, v16, 3, v21
    v_cmp_gt_u32 vcc, 18, v16
    v_mov_b32 v15, 2146435072
    s_nop 0
    v_cndmask_b32 v21, v15, v21, vcc
    s_cmp_lg_u32 s3, 1
    s_cbranch_scc1 L_noh1
    s_mul_i32 s67, s79, 144
    s_add_u32 s67, s67, 135168
    buffer_load_dwordx2 v[26:27], v21, s[48:51], s67 offen sc1
    s_mul_i32 s67, s79, 144
    s_add_u32 s67, s67, 172032
    buffer_load_dwordx2 v[28:29], v21, s[48:51], s67 offen sc1
    s_mul_i32 s67, s79, 144
    s_add_u32 s67, s67, 208896
    buffer_load_dwordx2 v[30:31], v21, s[48:51], s67 offen sc1
    s_mul_i32 s67, s79, 144
    s_add_u32 s67, s67, 245760
    buffer_load_dwordx2 v[32:33], v21, s[48:51], s67 offen sc1
L_noh1:
    s_waitcnt vmcnt(7)
    s_xor_b32 s66, s64, 0
    buffer_load_dwordx4 a[128:131], v4, s[32:35], s66 offen nt
    s_waitcnt vmcnt(7)
    s_xor_b32 s66, s64, 4096
    buffer_load_dwordx4 a[132:135], v4, s[32:35], s66 offen nt
    s_waitcnt vmcnt(7)
    s_xor_b32 s66, s64, 8192
    buffer_load_dwordx4 a[136:139], v4, s[32:35], s66 offen nt
    s_waitcnt vmcnt(7)
    s_xor_b32 s66, s64, 12288
    buffer_load_dwordx4 a[140:143], v4, s[32:35], s66 offen nt
    s_waitcnt vmcnt(7)
    s_xor_b32 s66, s64, 16384
    buffer_load_dwordx4 a[144:147], v4, s[32:35], s66 offen nt
    s_waitcnt vmcnt(7)
    s_xor_b32 s66, s64, 20480
    buffer_load_dwordx4 a[148:151], v4, s[32:35], s66 offen nt
    s_waitcnt vmcnt(7)
    s_xor_b32 s66, s64, 24576
    buffer_load_dwordx4 a[152:155], v4, s[32:35], s66 offen nt
    s_waitcnt vmcnt(7)
L_qchk:
    v_cmp_ne_u32 vcc, s62, v41
    v_cmp_ne_u32 s[70:71], s62, v43
    s_nop 0
    s_or_b64 s[70:71], s[70:71], vcc
    s_cbranch_scc0 L_qok
    s_cmp_eq_u32 s72, 0
    s_cbranch_scc1 L_qok
    s_sub_u32 s72, s72, 1
    s_lshl_b32 s68, s75, 15
    s_lshl_b32 s67, s76, 11
    s_add_u32 s68, s68, s67
    s_lshl_b32 s67, s3, 9
    s_add_u32 s68, s68, s67
    s_add_u32 s68, s68, 4096
    s_add_u32 s69, s68, 65536
    buffer_load_dwordx2 v[40:41], v39, s[48:51], s68 offen sc1
    buffer_load_dwordx2 v[42:43], v39, s[48:51], s69 offen sc1
    s_waitcnt vmcnt(0)
    s_branch L_qchk
L_qok:
    v_add_f32 v40, v40, v42
    v_cvt_pk_bf16_f32 v40, v40, v40
    s_lshl_b32 s67, s3, 7
    v_lshl_add_u32 v15, v0, 1, s67
    ds_write_b16 v15, v40 offset:6656
    v_lshrrev_b32 v16, 3, v2
    v_and_b32 v17, 3, v2
    v_lshl_add_u32 v17, v1, 2, v17
    v_lshlrev_b32 v17, 4, v17
    v_lshl_add_u32 v16, v16, 8, v17
    s_waitcnt lgkmcnt(0)
    s_barrier
    ds_read_b128 v[44:47], v16 offset:6656
    s_waitcnt lgkmcnt(0)
    v_mfma_f32_16x16x32_bf16 v[76:79], a[0:3], v[44:47], 0
    v_mfma_f32_16x16x32_bf16 v[80:83], a[4:7], v[44:47], 0
    v_mfma_f32_16x16x32_bf16 v[84:87], a[8:11], v[44:47], 0
    s_nop 5
    v_mov_b32_dpp v39, v76 quad_perm:[0,0,0,0] row_mask:0xf bank_mask:0xf
    v_add_f32_dpp v39, v77, v39 quad_perm:[1,1,1,1] row_mask:0xf bank_mask:0xf
    v_add_f32_dpp v39, v78, v39 quad_perm:[2,2,2,2] row_mask:0xf bank_mask:0xf
    v_add_f32_dpp v39, v79, v39 quad_perm:[3,3,3,3] row_mask:0xf bank_mask:0xf
    v_cvt_pk_bf16_f32 v39, 0, v39
    v_mul_f32 v39, s74, v39
    v_cvt_pk_bf16_f32 v39, 0, v39
    v_mfma_f32_16x16x32_bf16 v[76:79], a[12:15], v[44:47], 0
    v_mov_b32_dpp v40, v80 quad_perm:[0,0,0,0] row_mask:0xf bank_mask:0xf
    v_add_f32_dpp v40, v81, v40 quad_perm:[1,1,1,1] row_mask:0xf bank_mask:0xf
    v_add_f32_dpp v40, v82, v40 quad_perm:[2,2,2,2] row_mask:0xf bank_mask:0xf
    v_add_f32_dpp v40, v83, v40 quad_perm:[3,3,3,3] row_mask:0xf bank_mask:0xf
    v_cvt_pk_bf16_f32 v40, 0, v40
    v_mul_f32 v40, s74, v40
    v_cvt_pk_bf16_f32 v40, 0, v40
    v_max_f32 v75, v39, v40
    v_mfma_f32_16x16x32_bf16 v[80:83], a[16:19], v[44:47], 0
    v_mov_b32_dpp v41, v84 quad_perm:[0,0,0,0] row_mask:0xf bank_mask:0xf
    v_add_f32_dpp v41, v85, v41 quad_perm:[1,1,1,1] row_mask:0xf bank_mask:0xf
    v_add_f32_dpp v41, v86, v41 quad_perm:[2,2,2,2] row_mask:0xf bank_mask:0xf
    v_add_f32_dpp v41, v87, v41 quad_perm:[3,3,3,3] row_mask:0xf bank_mask:0xf
    v_cvt_pk_bf16_f32 v41, 0, v41
    v_mul_f32 v41, s74, v41
    v_cvt_pk_bf16_f32 v41, 0, v41
    v_mfma_f32_16x16x32_bf16 v[84:87], a[20:23], v[44:47], 0
    v_mov_b32_dpp v42, v76 quad_perm:[0,0,0,0] row_mask:0xf bank_mask:0xf
    v_add_f32_dpp v42, v77, v42 quad_perm:[1,1,1,1] row_mask:0xf bank_mask:0xf
    v_add_f32_dpp v42, v78, v42 quad_perm:[2,2,2,2] row_mask:0xf bank_mask:0xf
    v_add_f32_dpp v42, v79, v42 quad_perm:[3,3,3,3] row_mask:0xf bank_mask:0xf
    v_cvt_pk_bf16_f32 v42, 0, v42
    v_mul_f32 v42, s74, v42
    v_cvt_pk_bf16_f32 v42, 0, v42
    v_max3_f32 v75, v75, v41, v42
    s_waitcnt vmcnt(7)
    s_xor_b32 s66, s64, 28672
    buffer_load_dwordx4 a[156:159], v4, s[32:35], s66 offen nt
    v_mfma_f32_16x16x32_bf16 v[76:79], a[24:27], v[44:47], 0
    v_mov_b32_dpp v43, v80 quad_perm:[0,0,0,0] row_mask:0xf bank_mask:0xf
    v_add_f32_dpp v43, v81, v43 quad_perm:[1,1,1,1] row_mask:0xf bank_mask:0xf
    v_add_f32_dpp v43, v82, v43 quad_perm:[2,2,2,2] row_mask:0xf bank_mask:0xf
    v_add_f32_dpp v43, v83, v43 quad_perm:[3,3,3,3] row_mask:0xf bank_mask:0xf
    v_cvt_pk_bf16_f32 v43, 0, v43
    v_mul_f32 v43, s74, v43
    v_cvt_pk_bf16_f32 v43, 0, v43
    v_mfma_f32_16x16x32_bf16 v[80:83], a[28:31], v[44:47], 0
    v_mov_b32_dpp v48, v84 quad_perm:[0,0,0,0] row_mask:0xf bank_mask:0xf
    v_add_f32_dpp v48, v85, v48 quad_perm:[1,1,1,1] row_mask:0xf bank_mask:0xf
    v_add_f32_dpp v48, v86, v48 quad_perm:[2,2,2,2] row_mask:0xf bank_mask:0xf
    v_add_f32_dpp v48, v87, v48 quad_perm:[3,3,3,3] row_mask:0xf bank_mask:0xf
    v_cvt_pk_bf16_f32 v48, 0, v48
    v_mul_f32 v48, s74, v48
    v_cvt_pk_bf16_f32 v48, 0, v48
    v_max3_f32 v75, v75, v43, v48
    v_mfma_f32_16x16x32_bf16 v[84:87], a[32:35], v[44:47], 0
    v_mov_b32_dpp v49, v76 quad_perm:[0,0,0,0] row_mask:0xf bank_mask:0xf
    v_add_f32_dpp v49, v77, v49 quad_perm:[1,1,1,1] row_mask:0xf bank_mask:0xf
    v_add_f32_dpp v49, v78, v49 quad_perm:[2,2,2,2] row_mask:0xf bank_mask:0xf
    v_add_f32_dpp v49, v79, v49 quad_perm:[3,3,3,3] row_mask:0xf bank_mask:0xf
    v_cvt_pk_bf16_f32 v49, 0, v49
    v_mul_f32 v49, s74, v49
    v_cvt_pk_bf16_f32 v49, 0, v49
    v_mfma_f32_16x16x32_bf16 v[76:79], a[36:39], v[44:47], 0
    v_mov_b32_dpp v50, v80 quad_perm:[0,0,0,0] row_mask:0xf bank_mask:0xf
    v_add_f32_dpp v50, v81, v50 quad_perm:[1,1,1,1] row_mask:0xf bank_mask:0xf
    v_add_f32_dpp v50, v82, v50 quad_perm:[2,2,2,2] row_mask:0xf bank_mask:0xf
    v_add_f32_dpp v50, v83, v50 quad_perm:[3,3,3,3] row_mask:0xf bank_mask:0xf
    v_cvt_pk_bf16_f32 v50, 0, v50
    v_mul_f32 v50, s74, v50
    v_cvt_pk_bf16_f32 v50, 0, v50
    v_max3_f32 v75, v75, v49, v50
    v_mfma_f32_16x16x32_bf16 v[80:83], a[40:43], v[44:47], 0
    v_mov_b32_dpp v51, v84 quad_perm:[0,0,0,0] row_mask:0xf bank_mask:0xf
    v_add_f32_dpp v51, v85, v51 quad_perm:[1,1,1,1] row_mask:0xf bank_mask:0xf
    v_add_f32_dpp v51, v86, v51 quad_perm:[2,2,2,2] row_mask:0xf bank_mask:0xf
    v_add_f32_dpp v51, v87, v51 quad_perm:[3,3,3,3] row_mask:0xf bank_mask:0xf
    v_cvt_pk_bf16_f32 v51, 0, v51
    v_mul_f32 v51, s74, v51
    v_cvt_pk_bf16_f32 v51, 0, v51
    s_waitcnt vmcnt(7)
    s_xor_b32 s66, s64, 32768
    buffer_load_dwordx4 a[160:163], v4, s[32:35], s66 offen nt
    v_mfma_f32_16x16x32_bf16 v[84:87], a[44:47], v[44:47], 0
    v_mov_b32_dpp v52, v76 quad_perm:[0,0,0,0] row_mask:0xf bank_mask:0xf
    v_add_f32_dpp v52, v77, v52 quad_perm:[1,1,1,1] row_mask:0xf bank_mask:0xf
    v_add_f32_dpp v52, v78, v52 quad_perm:[2,2,2,2] row_mask:0xf bank_mask:0xf
    v_add_f32_dpp v52, v79, v52 quad_perm:[3,3,3,3] row_mask:0xf bank_mask:0xf
    v_cvt_pk_bf16_f32 v52, 0, v52
    v_mul_f32 v52, s74, v52
    v_cvt_pk_bf16_f32 v52, 0, v52
    v_max3_f32 v75, v75, v51, v52
    v_mfma_f32_16x16x32_bf16 v[76:79], a[48:51], v[44:47], 0
    v_mov_b32_dpp v53, v80 quad_perm:[0,0,0,0] row_mask:0xf bank_mask:0xf
    v_add_f32_dpp v53, v81, v53 quad_perm:[1,1,1,1] row_mask:0xf bank_mask:0xf
    v_add_f32_dpp v53, v82, v53 quad_perm:[2,2,2,2] row_mask:0xf bank_mask:0xf
    v_add_f32_dpp v53, v83, v53 quad_perm:[3,3,3,3] row_mask:0xf bank_mask:0xf
    v_cvt_pk_bf16_f32 v53, 0, v53
    v_mul_f32 v53, s74, v53
    v_cvt_pk_bf16_f32 v53, 0, v53
    v_mfma_f32_16x16x32_bf16 v[80:83], a[52:55], v[44:47], 0
    v_mov_b32_dpp v54, v84 quad_perm:[0,0,0,0] row_mask:0xf bank_mask:0xf
    v_add_f32_dpp v54, v85, v54 quad_perm:[1,1,1,1] row_mask:0xf bank_mask:0xf
    v_add_f32_dpp v54, v86, v54 quad_perm:[2,2,2,2] row_mask:0xf bank_mask:0xf
    v_add_f32_dpp v54, v87, v54 quad_perm:[3,3,3,3] row_mask:0xf bank_mask:0xf
    v_cvt_pk_bf16_f32 v54, 0, v54
    v_mul_f32 v54, s74, v54
    v_cvt_pk_bf16_f32 v54, 0, v54
    v_max3_f32 v75, v75, v53, v54
    v_mfma_f32_16x16x32_bf16 v[84:87], a[56:59], v[44:47], 0
    v_mov_b32_dpp v55, v76 quad_perm:[0,0,0,0] row_mask:0xf bank_mask:0xf
    v_add_f32_dpp v55, v77, v55 quad_perm:[1,1,1,1] row_mask:0xf bank_mask:0xf
    v_add_f32_dpp v55, v78, v55 quad_perm:[2,2,2,2] row_mask:0xf bank_mask:0xf
    v_add_f32_dpp v55, v79, v55 quad_perm:[3,3,3,3] row_mask:0xf bank_mask:0xf
    v_cvt_pk_bf16_f32 v55, 0, v55
    v_mul_f32 v55, s74, v55
    v_cvt_pk_bf16_f32 v55, 0, v55
    v_mfma_f32_16x16x32_bf16 v[76:79], a[60:63], v[44:47], 0
    v_mov_b32_dpp v56, v80 quad_perm:[0,0,0,0] row_mask:0xf bank_mask:0xf
    v_add_f32_dpp v56, v81, v56 quad_perm:[1,1,1,1] row_mask:0xf bank_mask:0xf
    v_add_f32_dpp v56, v82, v56 quad_perm:[2,2,2,2] row_mask:0xf bank_mask:0xf
    v_add_f32_dpp v56, v83, v56 quad_perm:[3,3,3,3] row_mask:0xf bank_mask:0xf
    v_cvt_pk_bf16_f32 v56, 0, v56
    v_mul_f32 v56, s74, v56
    v_cvt_pk_bf16_f32 v56, 0, v56
    v_max3_f32 v75, v75, v55, v56
    s_waitcnt vmcnt(7)
    s_xor_b32 s66, s64, 36864
    buffer_load_dwordx4 a[164:167], v4, s[32:35], s66 offen nt
    v_mfma_f32_16x16x32_bf16 v[80:83], a[64:67], v[44:47], 0
    v_mov_b32_dpp v57, v84 quad_perm:[0,0,0,0] row_mask:0xf bank_mask:0xf
    v_add_f32_dpp v57, v85, v57 quad_perm:[1,1,1,1] row_mask:0xf bank_mask:0xf
    v_add_f32_dpp v57, v86, v57 quad_perm:[2,2,2,2] row_mask:0xf bank_mask:0xf
    v_add_f32_dpp v57, v87, v57 quad_perm:[3,3,3,3] row_mask:0xf bank_mask:0xf
    v_cvt_pk_bf16_f32 v57, 0, v57
    v_mul_f32 v57, s74, v57
    v_cvt_pk_bf16_f32 v57, 0, v57
    v_mfma_f32_16x16x32_bf16 v[84:87], a[68:71], v[44:47], 0
    v_mov_b32_dpp v58, v76 quad_perm:[0,0,0,0] row_mask:0xf bank_mask:0xf
    v_add_f32_dpp v58, v77, v58 quad_perm:[1,1,1,1] row_mask:0xf bank_mask:0xf
    v_add_f32_dpp v58, v78, v58 quad_perm:[2,2,2,2] row_mask:0xf bank_mask:0xf
    v_add_f32_dpp v58, v79, v58 quad_perm:[3,3,3,3] row_mask:0xf bank_mask:0xf
    v_cvt_pk_bf16_f32 v58, 0, v58
    v_mul_f32 v58, s74, v58
    v_cvt_pk_bf16_f32 v58, 0, v58
    v_max3_f32 v75, v75, v57, v58
    v_mfma_f32_16x16x32_bf16 v[76:79], a[72:75], v[44:47], 0
    v_mov_b32_dpp v59, v80 quad_perm:[0,0,0,0] row_mask:0xf bank_mask:0xf
    v_add_f32_dpp v59, v81, v59 quad_perm:[1,1,1,1] row_mask:0xf bank_mask:0xf
    v_add_f32_dpp v59, v82, v59 quad_perm:[2,2,2,2] row_mask:0xf bank_mask:0xf
    v_add_f32_dpp v59, v83, v59 quad_perm:[3,3,3,3] row_mask:0xf bank_mask:0xf
    v_cvt_pk_bf16_f32 v59, 0, v59
    v_mul_f32 v59, s74, v59
    v_cvt_pk_bf16_f32 v59, 0, v59
    v_mfma_f32_16x16x32_bf16 v[80:83], a[76:79], v[44:47], 0
    v_mov_b32_dpp v60, v84 quad_perm:[0,0,0,0] row_mask:0xf bank_mask:0xf
    v_add_f32_dpp v60, v85, v60 quad_perm:[1,1,1,1] row_mask:0xf bank_mask:0xf
    v_add_f32_dpp v60, v86, v60 quad_perm:[2,2,2,2] row_mask:0xf bank_mask:0xf
    v_add_f32_dpp v60, v87, v60 quad_perm:[3,3,3,3] row_mask:0xf bank_mask:0xf
    v_cvt_pk_bf16_f32 v60, 0, v60
    v_mul_f32 v60, s74, v60
    v_cvt_pk_bf16_f32 v60, 0, v60
    v_max3_f32 v75, v75, v59, v60
    v_mfma_f32_16x16x32_bf16 v[84:87], a[80:83], v[44:47], 0
    v_mov_b32_dpp v61, v76 quad_perm:[0,0,0,0] row_mask:0xf bank_mask:0xf
    v_add_f32_dpp v61, v77, v61 quad_perm:[1,1,1,1] row_mask:0xf bank_mask:0xf
    v_add_f32_dpp v61, v78, v61 quad_perm:[2,2,2,2] row_mask:0xf bank_mask:0xf
    v_add_f32_dpp v61, v79, v61 quad_perm:[3,3,3,3] row_mask:0xf bank_mask:0xf
    v_cvt_pk_bf16_f32 v61, 0, v61
    v_mul_f32 v61, s74, v61
    v_cvt_pk_bf16_f32 v61, 0, v61
    s_waitcnt vmcnt(7)
    s_xor_b32 s66, s64, 40960
    buffer_load_dwordx4 a[168:171], v4, s[32:35], s66 offen nt
    v_mfma_f32_16x16x32_bf16 v[76:79], a[84:87], v[44:47], 0
    v_mov_b32_dpp v62, v80 quad_perm:[0,0,0,0] row_mask:0xf bank_mask:0xf
    v_add_f32_dpp v62, v81, v62 quad_perm:[1,1,1,1] row_mask:0xf bank_mask:0xf
    v_add_f32_dpp v62, v82, v62 quad_perm:[2,2,2,2] row_mask:0xf bank_mask:0xf
    v_add_f32_dpp v62, v83, v62 quad_perm:[3,3,3,3] row_mask:0xf bank_mask:0xf
    v_cvt_pk_bf16_f32 v62, 0, v62
    v_mul_f32 v62, s74, v62
    v_cvt_pk_bf16_f32 v62, 0, v62
    v_max3_f32 v75, v75, v61, v62
    v_mfma_f32_16x16x32_bf16 v[80:83], a[88:91], v[44:47], 0
    v_mov_b32_dpp v63, v84 quad_perm:[0,0,0,0] row_mask:0xf bank_mask:0xf
    v_add_f32_dpp v63, v85, v63 quad_perm:[1,1,1,1] row_mask:0xf bank_mask:0xf
    v_add_f32_dpp v63, v86, v63 quad_perm:[2,2,2,2] row_mask:0xf bank_mask:0xf
    v_add_f32_dpp v63, v87, v63 quad_perm:[3,3,3,3] row_mask:0xf bank_mask:0xf
    v_cvt_pk_bf16_f32 v63, 0, v63
    v_mul_f32 v63, s74, v63
    v_cvt_pk_bf16_f32 v63, 0, v63
    v_mfma_f32_16x16x32_bf16 v[84:87], a[92:95], v[44:47], 0
    v_mov_b32_dpp v64, v76 quad_perm:[0,0,0,0] row_mask:0xf bank_mask:0xf
    v_add_f32_dpp v64, v77, v64 quad_perm:[1,1,1,1] row_mask:0xf bank_mask:0xf
    v_add_f32_dpp v64, v78, v64 quad_perm:[2,2,2,2] row_mask:0xf bank_mask:0xf
    v_add_f32_dpp v64, v79, v64 quad_perm:[3,3,3,3] row_mask:0xf bank_mask:0xf
    v_cvt_pk_bf16_f32 v64, 0, v64
    v_mul_f32 v64, s74, v64
    v_cvt_pk_bf16_f32 v64, 0, v64
    v_max3_f32 v75, v75, v63, v64
    v_mfma_f32_16x16x32_bf16 v[76:79], a[96:99], v[44:47], 0
    v_mov_b32_dpp v65, v80 quad_perm:[0,0,0,0] row_mask:0xf bank_mask:0xf
    v_add_f32_dpp v65, v81, v65 quad_perm:[1,1,1,1] row_mask:0xf bank_mask:0xf
    v_add_f32_dpp v65, v82, v65 quad_perm:[2,2,2,2] row_mask:0xf bank_mask:0xf
    v_add_f32_dpp v65, v83, v65 quad_perm:[3,3,3,3] row_mask:0xf bank_mask:0xf
    v_cvt_pk_bf16_f32 v65, 0, v65
    v_mul_f32 v65, s74, v65
    v_cvt_pk_bf16_f32 v65, 0, v65
    v_mfma_f32_16x16x32_bf16 v[80:83], a[100:103], v[44:47], 0
    v_mov_b32_dpp v66, v84 quad_perm:[0,0,0,0] row_mask:0xf bank_mask:0xf
    v_add_f32_dpp v66, v85, v66 quad_perm:[1,1,1,1] row_mask:0xf bank_mask:0xf
    v_add_f32_dpp v66, v86, v66 quad_perm:[2,2,2,2] row_mask:0xf bank_mask:0xf
    v_add_f32_dpp v66, v87, v66 quad_perm:[3,3,3,3] row_mask:0xf bank_mask:0xf
    v_cvt_pk_bf16_f32 v66, 0, v66
    v_mul_f32 v66, s74, v66
    v_cvt_pk_bf16_f32 v66, 0, v66
    v_max3_f32 v75, v75, v65, v66
    s_waitcnt vmcnt(7)
    s_xor_b32 s66, s64, 45056
    buffer_load_dwordx4 a[172:175], v4, s[32:35], s66 offen nt
    v_mfma_f32_16x16x32_bf16 v[84:87], a[104:107], v[44:47], 0
    v_mov_b32_dpp v67, v76 quad_perm:[0,0,0,0] row_mask:0xf bank_mask:0xf
    v_add_f32_dpp v67, v77, v67 quad_perm:[1,1,1,1] row_mask:0xf bank_mask:0xf
    v_add_f32_dpp v67, v78, v67 quad_perm:[2,2,2,2] row_mask:0xf bank_mask:0xf
    v_add_f32_dpp v67, v79, v67 quad_perm:[3,3,3,3] row_mask:0xf bank_mask:0xf
    v_cvt_pk_bf16_f32 v67, 0, v67
    v_mul_f32 v67, s74, v67
    v_cvt_pk_bf16_f32 v67, 0, v67
    v_mfma_f32_16x16x32_bf16 v[76:79], a[108:111], v[44:47], 0
    v_mov_b32_dpp v68, v80 quad_perm:[0,0,0,0] row_mask:0xf bank_mask:0xf
    v_add_f32_dpp v68, v81, v68 quad_perm:[1,1,1,1] row_mask:0xf bank_mask:0xf
    v_add_f32_dpp v68, v82, v68 quad_perm:[2,2,2,2] row_mask:0xf bank_mask:0xf
    v_add_f32_dpp v68, v83, v68 quad_perm:[3,3,3,3] row_mask:0xf bank_mask:0xf
    v_cvt_pk_bf16_f32 v68, 0, v68
    v_mul_f32 v68, s74, v68
    v_cvt_pk_bf16_f32 v68, 0, v68
    v_max3_f32 v75, v75, v67, v68
    v_mfma_f32_16x16x32_bf16 v[80:83], a[112:115], v[44:47], 0
    v_mov_b32_dpp v69, v84 quad_perm:[0,0,0,0] row_mask:0xf bank_mask:0xf
    v_add_f32_dpp v69, v85, v69 quad_perm:[1,1,1,1] row_mask:0xf bank_mask:0xf
    v_add_f32_dpp v69, v86, v69 quad_perm:[2,2,2,2] row_mask:0xf bank_mask:0xf
    v_add_f32_dpp v69, v87, v69 quad_perm:[3,3,3,3] row_mask:0xf bank_mask:0xf
    v_cvt_pk_bf16_f32 v69, 0, v69
    v_mul_f32 v69, s74, v69
    v_cvt_pk_bf16_f32 v69, 0, v69
    v_mfma_f32_16x16x32_bf16 v[84:87], a[116:119], v[44:47], 0
    v_mov_b32_dpp v70, v76 quad_perm:[0,0,0,0] row_mask:0xf bank_mask:0xf
    v_add_f32_dpp v70, v77, v70 quad_perm:[1,1,1,1] row_mask:0xf bank_mask:0xf
    v_add_f32_dpp v70, v78, v70 quad_perm:[2,2,2,2] row_mask:0xf bank_mask:0xf
    v_add_f32_dpp v70, v79, v70 quad_perm:[3,3,3,3] row_mask:0xf bank_mask:0xf
    v_cvt_pk_bf16_f32 v70, 0, v70
    v_mul_f32 v70, s74, v70
    v_cvt_pk_bf16_f32 v70, 0, v70
    v_max3_f32 v75, v75, v69, v70
    v_mfma_f32_16x16x32_bf16 v[76:79], a[120:123], v[44:47], 0
    v_mov_b32_dpp v71, v80 quad_perm:[0,0,0,0] row_mask:0xf bank_mask:0xf
    v_add_f32_dpp v71, v81, v71 quad_perm:[1,1,1,1] row_mask:0xf bank_mask:0xf
    v_add_f32_dpp v71, v82, v71 quad_perm:[2,2,2,2] row_mask:0xf bank_mask:0xf
    v_add_f32_dpp v71, v83, v71 quad_perm:[3,3,3,3] row_mask:0xf bank_mask:0xf
    v_cvt_pk_bf16_f32 v71, 0, v71
    v_mul_f32 v71, s74, v71
    v_cvt_pk_bf16_f32 v71, 0, v71
    s_waitcnt vmcnt(7)
    s_xor_b32 s66, s64, 49152
    buffer_load_dwordx4 a[176:179], v4, s[32:35], s66 offen nt
    v_mfma_f32_16x16x32_bf16 v[80:83], a[124:127], v[44:47], 0
    v_mov_b32_dpp v72, v84 quad_perm:[0,0,0,0] row_mask:0xf bank_mask:0xf
    v_add_f32_dpp v72, v85, v72 quad_perm:[1,1,1,1] row_mask:0xf bank_mask:0xf
    v_add_f32_dpp v72, v86, v72 quad_perm:[2,2,2,2] row_mask:0xf bank_mask:0xf
    v_add_f32_dpp v72, v87, v72 quad_perm:[3,3,3,3] row_mask:0xf bank_mask:0xf
    v_cvt_pk_bf16_f32 v72, 0, v72
    v_mul_f32 v72, s74, v72
    v_cvt_pk_bf16_f32 v72, 0, v72
    v_max3_f32 v75, v75, v71, v72
    v_mov_b32_dpp v73, v76 quad_perm:[0,0,0,0] row_mask:0xf bank_mask:0xf
    v_add_f32_dpp v73, v77, v73 quad_perm:[1,1,1,1] row_mask:0xf bank_mask:0xf
    v_add_f32_dpp v73, v78, v73 quad_perm:[2,2,2,2] row_mask:0xf bank_mask:0xf
    v_add_f32_dpp v73, v79, v73 quad_perm:[3,3,3,3] row_mask:0xf bank_mask:0xf
    v_cvt_pk_bf16_f32 v73, 0, v73
    v_mul_f32 v73, s74, v73
    v_cvt_pk_bf16_f32 v73, 0, v73
    v_mov_b32_dpp v74, v80 quad_perm:[0,0,0,0] row_mask:0xf bank_mask:0xf
    v_add_f32_dpp v74, v81, v74 quad_perm:[1,1,1,1] row_mask:0xf bank_mask:0xf
    v_add_f32_dpp v74, v82, v74 quad_perm:[2,2,2,2] row_mask:0xf bank_mask:0xf
    v_add_f32_dpp v74, v83, v74 quad_perm:[3,3,3,3] row_mask:0xf bank_mask:0xf
    v_cvt_pk_bf16_f32 v74, 0, v74
    v_mul_f32 v74, s74, v74
    v_cvt_pk_bf16_f32 v74, 0, v74
    v_max3_f32 v75, v75, v73, v74
    v_mov_b32 v15, v75
    s_nop 1
    v_permlane16_swap_b32 v75, v15
    v_max_f32 v75, v75, v15
    v_mov_b32 v15, v75
    s_nop 1
    v_permlane32_swap_b32 v75, v15
    v_max_f32 v75, v75, v15
    v_mul_f32 v44, s73, v75
    v_fma_f32 v39, v39, s73, -v44
    v_exp_f32 v39, v39
    v_fma_f32 v40, v40, s73, -v44
    v_exp_f32 v40, v40
    s_nop 0
    v_add_f32 v15, v39, v40
    v_mov_b32 v88, v15
    v_cvt_pk_bf16_f32 v45, v39, v40
    v_fma_f32 v41, v41, s73, -v44
    v_exp_f32 v41, v41
    v_fma_f32 v42, v42, s73, -v44
    v_exp_f32 v42, v42
    s_nop 0
    v_add_f32 v15, v41, v42
    v_add_f32 v88, v88, v15
    v_cvt_pk_bf16_f32 v46, v41, v42
    v_fma_f32 v43, v43, s73, -v44
    v_exp_f32 v43, v43
    v_fma_f32 v48, v48, s73, -v44
    v_exp_f32 v48, v48
    s_nop 0
    v_add_f32 v15, v43, v48
    v_add_f32 v88, v88, v15
    v_cvt_pk_bf16_f32 v47, v43, v48
    v_fma_f32 v49, v49, s73, -v44
    v_exp_f32 v49, v49
    v_fma_f32 v50, v50, s73, -v44
    v_exp_f32 v50, v50
    s_nop 0
    v_add_f32 v15, v49, v50
    v_add_f32 v88, v88, v15
    v_cvt_pk_bf16_f32 v76, v49, v50
    v_fma_f32 v51, v51, s73, -v44
    v_exp_f32 v51, v51
    s_waitcnt vmcnt(7)
    s_xor_b32 s66, s64, 53248
    buffer_load_dwordx4 a[180:183], v4, s[32:35], s66 offen nt
    v_fma_f32 v52, v52, s73, -v44
    v_exp_f32 v52, v52
    s_nop 0
    v_add_f32 v15, v51, v52
    v_add_f32 v88, v88, v15
    v_cvt_pk_bf16_f32 v77, v51, v52
    v_fma_f32 v53, v53, s73, -v44
    v_exp_f32 v53, v53
    v_fma_f32 v54, v54, s73, -v44
    v_exp_f32 v54, v54
    s_nop 0
    v_add_f32 v15, v53, v54
    v_add_f32 v88, v88, v15
    v_cvt_pk_bf16_f32 v78, v53, v54
    v_fma_f32 v55, v55, s73, -v44
    v_exp_f32 v55, v55
    v_fma_f32 v56, v56, s73, -v44
    v_exp_f32 v56, v56
    s_nop 0
    v_add_f32 v15, v55, v56
    v_add_f32 v88, v88, v15
    v_cvt_pk_bf16_f32 v79, v55, v56
    v_fma_f32 v57, v57, s73, -v44
    v_exp_f32 v57, v57
    v_fma_f32 v58, v58, s73, -v44
    v_exp_f32 v58, v58
    s_nop 0
    v_add_f32 v15, v57, v58
    v_add_f32 v88, v88, v15
    v_cvt_pk_bf16_f32 v80, v57, v58
    v_fma_f32 v59, v59, s73, -v44
    v_exp_f32 v59, v59
    v_fma_f32 v60, v60, s73, -v44
    v_exp_f32 v60, v60
    s_nop 0
    v_add_f32 v15, v59, v60
    v_add_f32 v88, v88, v15
    v_cvt_pk_bf16_f32 v81, v59, v60
    v_fma_f32 v61, v61, s73, -v44
    v_exp_f32 v61, v61
    s_waitcnt vmcnt(7)
    s_xor_b32 s66, s64, 57344
    buffer_load_dwordx4 a[184:187], v4, s[32:35], s66 offen nt
    v_fma_f32 v62, v62, s73, -v44
    v_exp_f32 v62, v62
    s_nop 0
    v_add_f32 v15, v61, v62
    v_add_f32 v88, v88, v15
    v_cvt_pk_bf16_f32 v82, v61, v62
    v_fma_f32 v63, v63, s73, -v44
    v_exp_f32 v63, v63
    v_fma_f32 v64, v64, s73, -v44
    v_exp_f32 v64, v64
    s_nop 0
    v_add_f32 v15, v63, v64
    v_add_f32 v88, v88, v15
    v_cvt_pk_bf16_f32 v83, v63, v64
    v_fma_f32 v65, v65, s73, -v44
    v_exp_f32 v65, v65
    v_fma_f32 v66, v66, s73, -v44
    v_exp_f32 v66, v66
    s_nop 0
    v_add_f32 v15, v65, v66
    v_add_f32 v88, v88, v15
    v_cvt_pk_bf16_f32 v84, v65, v66
    v_fma_f32 v67, v67, s73, -v44
    v_exp_f32 v67, v67
    v_fma_f32 v68, v68, s73, -v44
    v_exp_f32 v68, v68
    s_nop 0
    v_add_f32 v15, v67, v68
    v_add_f32 v88, v88, v15
    v_cvt_pk_bf16_f32 v85, v67, v68
    v_fma_f32 v69, v69, s73, -v44
    v_exp_f32 v69, v69
    v_fma_f32 v70, v70, s73, -v44
    v_exp_f32 v70, v70
    s_nop 0
    v_add_f32 v15, v69, v70
    v_add_f32 v88, v88, v15
    v_cvt_pk_bf16_f32 v86, v69, v70
    v_fma_f32 v71, v71, s73, -v44
    v_exp_f32 v71, v71
    s_waitcnt vmcnt(7)
    s_xor_b32 s66, s64, 61440
    buffer_load_dwordx4 a[188:191], v4, s[32:35], s66 offen nt
    v_fma_f32 v72, v72, s73, -v44
    v_exp_f32 v72, v72
    s_nop 0
    v_add_f32 v15, v71, v72
    v_add_f32 v88, v88, v15
    v_cvt_pk_bf16_f32 v87, v71, v72
    v_fma_f32 v73, v73, s73, -v44
    v_exp_f32 v73, v73
    v_fma_f32 v74, v74, s73, -v44
    v_exp_f32 v74, v74
    s_nop 0
    v_add_f32 v15, v73, v74
    v_add_f32 v88, v88, v15
    v_cvt_pk_bf16_f32 v89, v73, v74
    v_mov_b32 v15, v88
    s_nop 1
    v_permlane16_swap_b32 v88, v15
    v_add_f32 v88, v88, v15
    v_mov_b32 v15, v88
    s_nop 1
    v_permlane32_swap_b32 v88, v15
    v_add_f32 v88, v88, v15
    v_mov_b32 v40, v75
    v_mov_b32 v41, v88
    v_lshrrev_b32 v15, 3, v2
    s_lshl_b32 s67, s3, 3
    v_lshl_add_u32 v15, v15, 5, s67
    ds_write_b64 v15, v[40:41] offset:7168
    v_perm_b32 v128, v45, v45, v7
    v_perm_b32 v129, v45, v45, v8
    v_perm_b32 v130, v45, v45, v9
    v_perm_b32 v131, v45, v45, v10
    s_waitcnt vmcnt(15)
    s_nop 0
    v_mfma_f32_16x16x32_bf16 v[136:139], v[128:131], a[128:131], 0
    v_perm_b32 v132, v45, v45, v11
    v_perm_b32 v133, v45, v45, v12
    v_perm_b32 v134, v45, v45, v13
    v_perm_b32 v135, v45, v45, v14
    s_waitcnt vmcnt(14)
    s_nop 0
    v_mfma_f32_16x16x32_bf16 v[136:139], v[132:135], a[132:135], v[136:139]
    v_perm_b32 v128, v46, v46, v7
    v_perm_b32 v129, v46, v46, v8
    v_perm_b32 v130, v46, v46, v9
    v_perm_b32 v131, v46, v46, v10
    s_waitcnt vmcnt(13)
    s_nop 0
    v_mfma_f32_16x16x32_bf16 v[136:139], v[128:131], a[136:139], v[136:139]
    v_perm_b32 v132, v46, v46, v11
    v_perm_b32 v133, v46, v46, v12
    v_perm_b32 v134, v46, v46, v13
    v_perm_b32 v135, v46, v46, v14
    s_waitcnt vmcnt(12)
    s_nop 0
    v_mfma_f32_16x16x32_bf16 v[136:139], v[132:135], a[140:143], v[136:139]
    v_perm_b32 v128, v47, v47, v7
    v_perm_b32 v129, v47, v47, v8
    v_perm_b32 v130, v47, v47, v9
    v_perm_b32 v131, v47, v47, v10
    s_waitcnt vmcnt(11)
    s_nop 0
    v_mfma_f32_16x16x32_bf16 v[136:139], v[128:131], a[144:147], v[136:139]
    s_waitcnt lgkmcnt(0)
    s_barrier
    v_lshrrev_b32 v15, 1, v1
    v_lshlrev_b32 v15, 5, v15
    s_lshl_b32 s67, s3, 3
    v_add_u32 v16, s67, v15
    ds_read_b128 v[152:155], v15 offset:7168
    ds_read_b128 v[156:159], v15 offset:7184
    ds_read_b32 v39, v16 offset:7168
    s_waitcnt lgkmcnt(0)
    v_max3_f32 v88, v152, v154, v156
    v_max_f32 v88, v88, v158
    v_sub_f32 v39, v39, v88
    v_mul_f32 v39, s73, v39
    v_exp_f32 v39, v39
    s_cmp_lg_u32 s3, 0
    s_cbranch_scc1 L_nostat
    v_sub_f32 v152, v152, v88
    v_mul_f32 v152, s73, v152
    v_exp_f32 v152, v152
    v_sub_f32 v154, v154, v88
    v_mul_f32 v154, s73, v154
    v_exp_f32 v154, v154
    v_sub_f32 v156, v156, v88
    v_mul_f32 v156, s73, v156
    v_exp_f32 v156, v156
    v_sub_f32 v158, v158, v88
    v_mul_f32 v158, s73, v158
    v_exp_f32 v158, v158
    v_mul_f32 v15, v152, v153
    v_fmac_f32 v15, v154, v155
    v_fmac_f32 v15, v156, v157
    v_fmac_f32 v15, v158, v159
    v_readlane_b32 s68, v88, 32
    v_readlane_b32 s69, v15, 32
    v_mov_b32 v152, v88
    v_mov_b32 v153, v15
    v_mov_b32 v154, s68
    v_mov_b32 v155, s69
    v_and_or_b32 v152, v152, v5, s63
    v_and_or_b32 v153, v153, v5, s63
    v_and_or_b32 v154, v154, v5, s63
    v_and_or_b32 v155, v155, v5, s63
    s_lshl_b32 s67, s76, 8
    s_lshl_b32 s68, s75, 7
    s_add_u32 s67, s67, s68
    s_lshl_b32 s68, s77, 4
    s_add_u32 s67, s67, s68
    s_add_u32 s67, s67, 282624
    v_cmp_eq_u32 vcc, 0, v0
    v_mov_b32 v16, 2146435072
    s_nop 0
    v_cndmask_b32 v16, v16, 0, vcc
    buffer_store_dwordx4 v[152:155], v16, s[48:51], s67 offen sc1
L_nostat:
    v_perm_b32 v132, v47, v47, v11
    v_perm_b32 v133, v47, v47, v12
    v_perm_b32 v134, v47, v47, v13
    v_perm_b32 v135, v47, v47, v14
    s_waitcnt vmcnt(10)
    s_nop 0
    v_mfma_f32_16x16x32_bf16 v[136:139], v[132:135], a[148:151], v[136:139]
    v_perm_b32 v128, v76, v76, v7
    v_perm_b32 v129, v76, v76, v8
    v_perm_b32 v130, v76, v76, v9
    v_perm_b32 v131, v76, v76, v10
    s_waitcnt vmcnt(9)
    s_nop 0
    v_mfma_f32_16x16x32_bf16 v[136:139], v[128:131], a[152:155], v[136:139]
    v_perm_b32 v132, v76, v76, v11
    v_perm_b32 v133, v76, v76, v12
    v_perm_b32 v134, v76, v76, v13
    v_perm_b32 v135, v76, v76, v14
    s_waitcnt vmcnt(8)
    s_nop 0
    v_mfma_f32_16x16x32_bf16 v[136:139], v[132:135], a[156:159], v[136:139]
    v_perm_b32 v128, v77, v77, v7
    v_perm_b32 v129, v77, v77, v8
    v_perm_b32 v130, v77, v77, v9
    v_perm_b32 v131, v77, v77, v10
    s_waitcnt vmcnt(7)
    s_nop 0
    v_mfma_f32_16x16x32_bf16 v[136:139], v[128:131], a[160:163], v[136:139]
    s_xor_b32 s66, s64, 65536
    buffer_load_dwordx4 a[192:195], v4, s[32:35], s66 offen nt
    v_perm_b32 v132, v77, v77, v11
    v_perm_b32 v133, v77, v77, v12
    v_perm_b32 v134, v77, v77, v13
    v_perm_b32 v135, v77, v77, v14
    s_waitcnt vmcnt(7)
    s_nop 0
    v_mfma_f32_16x16x32_bf16 v[136:139], v[132:135], a[164:167], v[136:139]
    s_xor_b32 s66, s64, 69632
    buffer_load_dwordx4 a[196:199], v4, s[32:35], s66 offen nt
    s_cmp_lg_u32 s3, 1
    s_cbranch_scc1 L_noh2
    s_waitcnt vmcnt(18)
L_hchk:
    v_and_b32 v17, 31, v0
    v_cmp_gt_u32 s[68:69], 18, v17
    v_bitop3_b32 v15, v26, v27, s63 bitop3:0x7e
    v_bitop3_b32 v16, v28, v29, s63 bitop3:0x7e
    v_bitop3_b32 v19, v30, v31, s63 bitop3:0x7e
    v_bitop3_b32 v20, v32, v33, s63 bitop3:0x7e
    v_or3_b32 v15, v15, v16, v19
    v_or_b32 v15, v15, v20
    v_and_b32 v15, 255, v15
    v_cmp_ne_u32 vcc, 0, v15
    s_nop 0
    s_and_b64 s[70:71], vcc, s[68:69]
    s_cbranch_scc0 L_hok
    s_cmp_eq_u32 s72, 0
    s_cbranch_scc1 L_hok
    s_sub_u32 s72, s72, 1
    s_mul_i32 s67, s79, 144
    s_add_u32 s67, s67, 135168
    buffer_load_dwordx2 v[26:27], v21, s[48:51], s67 offen sc1
    s_mul_i32 s67, s79, 144
    s_add_u32 s67, s67, 172032
    buffer_load_dwordx2 v[28:29], v21, s[48:51], s67 offen sc1
    s_mul_i32 s67, s79, 144
    s_add_u32 s67, s67, 208896
    buffer_load_dwordx2 v[30:31], v21, s[48:51], s67 offen sc1
    s_mul_i32 s67, s79, 144
    s_add_u32 s67, s67, 245760
    buffer_load_dwordx2 v[32:33], v21, s[48:51], s67 offen sc1
    s_waitcnt vmcnt(0)
    s_branch L_hchk
L_hok:
    v_and_b32 v26, v26, v5
    v_and_b32 v27, v27, v5
    v_and_b32 v28, v28, v5
    v_and_b32 v29, v29, v5
    v_and_b32 v30, v30, v5
    v_and_b32 v31, v31, v5
    v_and_b32 v32, v32, v5
    v_and_b32 v33, v33, v5
    v_add_f32 v26, v26, v28
    v_add_f32 v30, v30, v32
    v_cvt_pk_bf16_f32 v26, 0, v26
    v_cvt_pk_bf16_f32 v30, 0, v30
    v_mul_f32 v15, s73, v26
    v_exp_f32 v15, -v15
    s_nop 0
    v_add_f32 v15, 1.0, v15
    v_rcp_f32 v15, v15
    s_nop 0
    v_mul_f32 v26, v26, v15
    v_cvt_pk_bf16_f32 v26, 0, v26
    v_mul_f32 v26, v26, v30
    v_cvt_pk_bf16_f32 v26, v26, v26
    v_and_b32 v15, 31, v0
    v_lshl_add_u32 v15, v15, 1, 0
    v_mul_u32_u24 v16, 57, v15
    v_lshrrev_b32 v16, 9, v16
    v_mul_u32_u24 v17, 9, v16
    v_sub_u32 v15, v15, v17
    v_lshlrev_b32 v15, 1, v15
    v_lshl_add_u32 v15, v16, 5, v15
    v_lshrrev_b32 v16, 5, v0
    v_lshl_add_u32 v15, v16, 7, v15
    s_mov_b64 s[70:71], exec
    s_mov_b64 exec, s[68:69]
    ds_write_b16 v15, v26 offset:7424
    s_mov_b64 exec, s[70:71]
    v_add_f32 v27, v27, v29
    v_add_f32 v31, v31, v33
    v_cvt_pk_bf16_f32 v27, 0, v27
    v_cvt_pk_bf16_f32 v31, 0, v31
    v_mul_f32 v15, s73, v27
    v_exp_f32 v15, -v15
    s_nop 0
    v_add_f32 v15, 1.0, v15
    v_rcp_f32 v15, v15
    s_nop 0
    v_mul_f32 v27, v27, v15
    v_cvt_pk_bf16_f32 v27, 0, v27
    v_mul_f32 v27, v27, v31
    v_cvt_pk_bf16_f32 v27, v27, v27
    v_and_b32 v15, 31, v0
    v_lshl_add_u32 v15, v15, 1, 1
    v_mul_u32_u24 v16, 57, v15
    v_lshrrev_b32 v16, 9, v16
    v_mul_u32_u24 v17, 9, v16
    v_sub_u32 v15, v15, v17
    v_lshlrev_b32 v15, 1, v15
    v_lshl_add_u32 v15, v16, 5, v15
    v_lshrrev_b32 v16, 5, v0
    v_lshl_add_u32 v15, v16, 7, v15
    s_mov_b64 s[70:71], exec
    s_mov_b64 exec, s[68:69]
    ds_write_b16 v15, v27 offset:7424
    s_mov_b64 exec, s[70:71]
L_noh2:
    s_barrier
    v_perm_b32 v128, v78, v78, v7
    v_perm_b32 v129, v78, v78, v8
    v_perm_b32 v130, v78, v78, v9
    v_perm_b32 v131, v78, v78, v10
    s_waitcnt vmcnt(7)
    s_nop 0
    v_mfma_f32_16x16x32_bf16 v[136:139], v[128:131], a[168:171], v[136:139]
    s_xor_b32 s66, s64, 73728
    buffer_load_dwordx4 a[200:203], v4, s[32:35], s66 offen nt
    v_perm_b32 v132, v78, v78, v11
    v_perm_b32 v133, v78, v78, v12
    v_perm_b32 v134, v78, v78, v13
    v_perm_b32 v135, v78, v78, v14
    s_waitcnt vmcnt(7)
    s_nop 0
    v_mfma_f32_16x16x32_bf16 v[136:139], v[132:135], a[172:175], v[136:139]
    s_xor_b32 s66, s64, 77824
    buffer_load_dwordx4 a[204:207], v4, s[32:35], s66 offen nt
    v_perm_b32 v128, v79, v79, v7
    v_perm_b32 v129, v79, v79, v8
    v_perm_b32 v130, v79, v79, v9
    v_perm_b32 v131, v79, v79, v10
    s_waitcnt vmcnt(7)
    s_nop 0
    v_mfma_f32_16x16x32_bf16 v[136:139], v[128:131], a[176:179], v[136:139]
    s_xor_b32 s66, s64, 81920
    buffer_load_dwordx4 a[208:211], v4, s[32:35], s66 offen nt
    v_perm_b32 v132, v79, v79, v11
    v_perm_b32 v133, v79, v79, v12
    v_perm_b32 v134, v79, v79, v13
    v_perm_b32 v135, v79, v79, v14
    s_waitcnt vmcnt(7)
    s_nop 0
    v_mfma_f32_16x16x32_bf16 v[136:139], v[132:135], a[180:183], v[136:139]
    s_xor_b32 s66, s64, 86016
    buffer_load_dwordx4 a[212:215], v4, s[32:35], s66 offen nt
    s_barrier
    v_perm_b32 v128, v80, v80, v7
    v_perm_b32 v129, v80, v80, v8
    v_perm_b32 v130, v80, v80, v9
    v_perm_b32 v131, v80, v80, v10
    s_waitcnt vmcnt(7)
    s_nop 0
    v_mfma_f32_16x16x32_bf16 v[136:139], v[128:131], a[184:187], v[136:139]
    s_xor_b32 s66, s64, 90112
    buffer_load_dwordx4 a[216:219], v4, s[32:35], s66 offen nt
    v_perm_b32 v132, v80, v80, v11
    v_perm_b32 v133, v80, v80, v12
    v_perm_b32 v134, v80, v80, v13
    v_perm_b32 v135, v80, v80, v14
    s_waitcnt vmcnt(7)
    s_nop 0
    v_mfma_f32_16x16x32_bf16 v[136:139], v[132:135], a[188:191], v[136:139]
    s_xor_b32 s66, s64, 94208
    buffer_load_dwordx4 a[220:223], v4, s[32:35], s66 offen nt
    v_perm_b32 v128, v81, v81, v7
    v_perm_b32 v129, v81, v81, v8
    v_perm_b32 v130, v81, v81, v9
    v_perm_b32 v131, v81, v81, v10
    s_waitcnt vmcnt(7)
    s_nop 0
    v_mfma_f32_16x16x32_bf16 v[136:139], v[128:131], a[192:195], v[136:139]
    s_xor_b32 s66, s64, 98304
    buffer_load_dwordx4 a[224:227], v4, s[32:35], s66 offen nt
    v_perm_b32 v132, v81, v81, v11
    v_perm_b32 v133, v81, v81, v12
    v_perm_b32 v134, v81, v81, v13
    v_perm_b32 v135, v81, v81, v14
    s_waitcnt vmcnt(7)
    s_nop 0
    v_mfma_f32_16x16x32_bf16 v[136:139], v[132:135], a[196:199], v[136:139]
    s_xor_b32 s66, s64, 102400
    buffer_load_dwordx4 a[228:231], v4, s[32:35], s66 offen nt
    s_barrier
    v_perm_b32 v128, v82, v82, v7
    v_perm_b32 v129, v82, v82, v8
    v_perm_b32 v130, v82, v82, v9
    v_perm_b32 v131, v82, v82, v10
    s_waitcnt vmcnt(7)
    s_nop 0
    v_mfma_f32_16x16x32_bf16 v[136:139], v[128:131], a[200:203], v[136:139]
    s_xor_b32 s66, s64, 106496
    buffer_load_dwordx4 a[232:235], v4, s[32:35], s66 offen nt
    v_perm_b32 v132, v82, v82, v11
    v_perm_b32 v133, v82, v82, v12
    v_perm_b32 v134, v82, v82, v13
    v_perm_b32 v135, v82, v82, v14
    s_waitcnt vmcnt(7)
    s_nop 0
    v_mfma_f32_16x16x32_bf16 v[136:139], v[132:135], a[204:207], v[136:139]
    s_xor_b32 s66, s64, 110592
    buffer_load_dwordx4 a[236:239], v4, s[32:35], s66 offen nt
    v_perm_b32 v128, v83, v83, v7
    v_perm_b32 v129, v83, v83, v8
    v_perm_b32 v130, v83, v83, v9
    v_perm_b32 v131, v83, v83, v10
    s_waitcnt vmcnt(7)
    s_nop 0
    v_mfma_f32_16x16x32_bf16 v[136:139], v[128:131], a[208:211], v[136:139]
    s_xor_b32 s66, s64, 114688
    buffer_load_dwordx4 a[240:243], v4, s[32:35], s66 offen nt
    v_perm_b32 v132, v83, v83, v11
    v_perm_b32 v133, v83, v83, v12
    v_perm_b32 v134, v83, v83, v13
    v_perm_b32 v135, v83, v83, v14
    s_waitcnt vmcnt(7)
    s_nop 0
    v_mfma_f32_16x16x32_bf16 v[136:139], v[132:135], a[212:215], v[136:139]
    s_xor_b32 s66, s64, 118784
    buffer_load_dwordx4 a[244:247], v4, s[32:35], s66 offen nt
    s_barrier
    v_perm_b32 v128, v84, v84, v7
    v_perm_b32 v129, v84, v84, v8
    v_perm_b32 v130, v84, v84, v9
    v_perm_b32 v131, v84, v84, v10
    s_waitcnt vmcnt(7)
    s_nop 0
    v_mfma_f32_16x16x32_bf16 v[136:139], v[128:131], a[216:219], v[136:139]
    s_xor_b32 s66, s64, 122880
    buffer_load_dwordx4 a[248:251], v4, s[32:35], s66 offen nt
    v_perm_b32 v132, v84, v84, v11
    v_perm_b32 v133, v84, v84, v12
    v_perm_b32 v134, v84, v84, v13
    v_perm_b32 v135, v84, v84, v14
    s_waitcnt vmcnt(7)
    s_nop 0
    v_mfma_f32_16x16x32_bf16 v[136:139], v[132:135], a[220:223], v[136:139]
    s_xor_b32 s66, s64, 126976
    buffer_load_dwordx4 a[252:255], v4, s[32:35], s66 offen nt
    s_barrier
    s_cmp_eq_u32 s3, 0
    s_cbranch_scc1 L_pv0
    v_perm_b32 v128, v85, v85, v7
    v_perm_b32 v129, v85, v85, v8
    v_perm_b32 v130, v85, v85, v9
    v_perm_b32 v131, v85, v85, v10
    s_waitcnt vmcnt(7)
    s_nop 0
    v_mfma_f32_16x16x32_bf16 v[136:139], v[128:131], a[224:227], v[136:139]
    buffer_load_dwordx4 v[40:43], v36, s[44:47], 0 offen offset:0 nt
    buffer_load_dwordx4 v[48:51], v36, s[44:47], 0 offen offset:1152 nt
    v_perm_b32 v132, v85, v85, v11
    v_perm_b32 v133, v85, v85, v12
    v_perm_b32 v134, v85, v85, v13
    v_perm_b32 v135, v85, v85, v14
    s_waitcnt vmcnt(8)
    s_nop 0
    v_mfma_f32_16x16x32_bf16 v[136:139], v[132:135], a[228:231], v[136:139]
    buffer_load_dwordx4 v[52:55], v36, s[44:47], 0 offen offset:2304 nt
    buffer_load_dwordx4 v[56:59], v36, s[44:47], 0 offen offset:3456 nt
    v_perm_b32 v128, v86, v86, v7
    v_perm_b32 v129, v86, v86, v8
    v_perm_b32 v130, v86, v86, v9
    v_perm_b32 v131, v86, v86, v10
    s_waitcnt vmcnt(9)
    s_nop 0
    v_mfma_f32_16x16x32_bf16 v[136:139], v[128:131], a[232:235], v[136:139]
    buffer_load_dwordx4 v[60:63], v36, s[44:47], s85 offen offset:0 nt
    buffer_load_dwordx4 v[64:67], v36, s[44:47], s85 offen offset:1152 nt
    v_perm_b32 v132, v86, v86, v11
    v_perm_b32 v133, v86, v86, v12
    v_perm_b32 v134, v86, v86, v13
    v_perm_b32 v135, v86, v86, v14
    s_waitcnt vmcnt(10)
    s_nop 0
    v_mfma_f32_16x16x32_bf16 v[136:139], v[132:135], a[236:239], v[136:139]
    buffer_load_dwordx4 v[68:71], v36, s[44:47], s85 offen offset:2304 nt
    buffer_load_dwordx4 v[72:75], v36, s[44:47], s85 offen offset:3456 nt
    v_perm_b32 v128, v87, v87, v7
    v_perm_b32 v129, v87, v87, v8
    v_perm_b32 v130, v87, v87, v9
    v_perm_b32 v131, v87, v87, v10
    s_waitcnt vmcnt(11)
    s_nop 0
    v_mfma_f32_16x16x32_bf16 v[136:139], v[128:131], a[240:243], v[136:139]
    buffer_load_dwordx4 v[90:93], v36, s[44:47], s86 offen offset:0 nt
    buffer_load_dwordx4 v[94:97], v37, s[40:43], 0 offen offset:0 nt
    v_perm_b32 v132, v87, v87, v11
    v_perm_b32 v133, v87, v87, v12
    v_perm_b32 v134, v87, v87, v13
    v_perm_b32 v135, v87, v87, v14
    s_waitcnt vmcnt(12)
    s_nop 0
    v_mfma_f32_16x16x32_bf16 v[136:139], v[132:135], a[244:247], v[136:139]
    buffer_load_dwordx4 v[98:101], v37, s[40:43], 0 offen offset:1152 nt
    buffer_load_dwordx4 v[102:105], v37, s[40:43], 0 offen offset:2304 nt
    v_perm_b32 v128, v89, v89, v7
    v_perm_b32 v129, v89, v89, v8
    v_perm_b32 v130, v89, v89, v9
    v_perm_b32 v131, v89, v89, v10
    s_waitcnt vmcnt(13)
    s_nop 0
    v_mfma_f32_16x16x32_bf16 v[136:139], v[128:131], a[248:251], v[136:139]
    buffer_load_dwordx4 v[106:109], v37, s[40:43], 0 offen offset:3456 nt
    buffer_load_dwordx4 v[110:113], v37, s[40:43], s85 offen offset:0 nt
    v_perm_b32 v132, v89, v89, v11
    v_perm_b32 v133, v89, v89, v12
    v_perm_b32 v134, v89, v89, v13
    v_perm_b32 v135, v89, v89, v14
    s_waitcnt vmcnt(14)
    s_nop 0
    v_mfma_f32_16x16x32_bf16 v[136:139], v[132:135], a[252:255], v[136:139]
    buffer_load_dwordx4 v[114:117], v37, s[40:43], s85 offen offset:1152 nt
    buffer_load_dwordx4 v[118:121], v37, s[40:43], s85 offen offset:2304 nt
    buffer_load_dwordx4 v[122:125], v37, s[40:43], s85 offen offset:3456 nt
    s_branch L_pvend
L_pv0:
    v_perm_b32 v128, v85, v85, v7
    v_perm_b32 v129, v85, v85, v8
    v_perm_b32 v130, v85, v85, v9
    v_perm_b32 v131, v85, v85, v10
    s_waitcnt vmcnt(7)
    s_nop 0
    v_mfma_f32_16x16x32_bf16 v[136:139], v[128:131], a[224:227], v[136:139]
    v_perm_b32 v132, v85, v85, v11
    v_perm_b32 v133, v85, v85, v12
    v_perm_b32 v134, v85, v85, v13
    v_perm_b32 v135, v85, v85, v14
    s_waitcnt vmcnt(6)
    s_nop 0
    v_mfma_f32_16x16x32_bf16 v[136:139], v[132:135], a[228:231], v[136:139]
    v_perm_b32 v128, v86, v86, v7
    v_perm_b32 v129, v86, v86, v8
    v_perm_b32 v130, v86, v86, v9
    v_perm_b32 v131, v86, v86, v10
    s_waitcnt vmcnt(5)
    s_nop 0
    v_mfma_f32_16x16x32_bf16 v[136:139], v[128:131], a[232:235], v[136:139]
    v_perm_b32 v132, v86, v86, v11
    v_perm_b32 v133, v86, v86, v12
    v_perm_b32 v134, v86, v86, v13
    v_perm_b32 v135, v86, v86, v14
    s_waitcnt vmcnt(4)
    s_nop 0
    v_mfma_f32_16x16x32_bf16 v[136:139], v[132:135], a[236:239], v[136:139]
    v_perm_b32 v128, v87, v87, v7
    v_perm_b32 v129, v87, v87, v8
    v_perm_b32 v130, v87, v87, v9
    v_perm_b32 v131, v87, v87, v10
    s_waitcnt vmcnt(3)
    s_nop 0
    v_mfma_f32_16x16x32_bf16 v[136:139], v[128:131], a[240:243], v[136:139]
    v_perm_b32 v132, v87, v87, v11
    v_perm_b32 v133, v87, v87, v12
    v_perm_b32 v134, v87, v87, v13
    v_perm_b32 v135, v87, v87, v14
    s_waitcnt vmcnt(2)
    s_nop 0
    v_mfma_f32_16x16x32_bf16 v[136:139], v[132:135], a[244:247], v[136:139]
    v_cmp_gt_u32 vcc, 16, v0
    v_mov_b32 v16, 2146435072
    s_nop 0
    v_cndmask_b32 v44, v16, v4, vcc
    s_lshl_b32 s67, s76, 8
    s_add_u32 s67, s67, 282624
    buffer_load_dwordx4 v[140:143], v44, s[48:51], s67 offen sc1
    v_perm_b32 v128, v89, v89, v7
    v_perm_b32 v129, v89, v89, v8
    v_perm_b32 v130, v89, v89, v9
    v_perm_b32 v131, v89, v89, v10
    s_waitcnt vmcnt(2)
    s_nop 0
    v_mfma_f32_16x16x32_bf16 v[136:139], v[128:131], a[248:251], v[136:139]
    v_perm_b32 v132, v89, v89, v11
    v_perm_b32 v133, v89, v89, v12
    v_perm_b32 v134, v89, v89, v13
    v_perm_b32 v135, v89, v89, v14
    s_waitcnt vmcnt(1)
    s_nop 0
    v_mfma_f32_16x16x32_bf16 v[136:139], v[132:135], a[252:255], v[136:139]
L_pvend:
    s_nop 7
    v_mul_f32 v136, v136, v39
    v_mul_f32 v137, v137, v39
    v_mul_f32 v138, v138, v39
    v_mul_f32 v139, v139, v39
    s_lshl_b32 s67, s3, 10
    v_add_u32 v15, s67, v6
    ds_write_b128 v15, v[136:139] offset:7680
    v_lshrrev_b32 v15, 3, v0
    v_and_b32 v16, 7, v0
    v_lshlrev_b32 v16, 4, v16
    v_lshl_add_u32 v172, v15, 11, v16
    v_lshlrev_b32 v173, 2, v0
    s_lshl_b32 s87, s76, 14
    s_lshl_b32 s67, s77, 8
    s_add_u32 s87, s87, s67
    s_lshl_b32 s67, s75, 7
    s_add_u32 s87, s87, s67
    s_add_u32 s87, s87, 286720
    s_lshl_b32 s88, s80, 11
    s_add_u32 s88, s88, 286720
    s_waitcnt lgkmcnt(0)
    s_barrier
    s_cmp_eq_u32 s3, 0
    s_cbranch_scc1 L_comm
    v_lshrrev_b32 v178, 3, v2
    v_lshlrev_b32 v178, 7, v178
    v_lshl_add_u32 v178, v1, 5, v178
    ds_read_b128 v[174:177], v178 offset:7424
    ds_read_b32 v178, v178 offset:7440
    s_waitcnt lgkmcnt(0)
    v_perm_b32 v128, v174, v174, v7
    v_perm_b32 v129, v174, v174, v8
    v_perm_b32 v130, v174, v174, v9
    v_perm_b32 v131, v174, v174, v10
    s_waitcnt vmcnt(16)
    s_nop 0
    v_mfma_f32_16x16x32_bf16 v[180:183], v[128:131], v[40:43], 0
    v_perm_b32 v132, v174, v174, v11
    v_perm_b32 v133, v174, v174, v12
    v_perm_b32 v134, v174, v174, v13
    v_perm_b32 v135, v174, v174, v14
    s_waitcnt vmcnt(15)
    s_nop 0
    v_mfma_f32_16x16x32_bf16 v[180:183], v[132:135], v[48:51], v[180:183]
    v_perm_b32 v128, v175, v175, v7
    v_perm_b32 v129, v175, v175, v8
    v_perm_b32 v130, v175, v175, v9
    v_perm_b32 v131, v175, v175, v10
    s_waitcnt vmcnt(14)
    s_nop 0
    v_mfma_f32_16x16x32_bf16 v[180:183], v[128:131], v[52:55], v[180:183]
    v_perm_b32 v132, v175, v175, v11
    v_perm_b32 v133, v175, v175, v12
    v_perm_b32 v134, v175, v175, v13
    v_perm_b32 v135, v175, v175, v14
    s_waitcnt vmcnt(13)
    s_nop 0
    v_mfma_f32_16x16x32_bf16 v[180:183], v[132:135], v[56:59], v[180:183]
    v_perm_b32 v128, v176, v176, v7
    v_perm_b32 v129, v176, v176, v8
    v_perm_b32 v130, v176, v176, v9
    v_perm_b32 v131, v176, v176, v10
    s_waitcnt vmcnt(12)
    s_nop 0
    v_mfma_f32_16x16x32_bf16 v[180:183], v[128:131], v[60:63], v[180:183]
    v_perm_b32 v132, v176, v176, v11
    v_perm_b32 v133, v176, v176, v12
    v_perm_b32 v134, v176, v176, v13
    v_perm_b32 v135, v176, v176, v14
    s_waitcnt vmcnt(11)
    s_nop 0
    v_mfma_f32_16x16x32_bf16 v[180:183], v[132:135], v[64:67], v[180:183]
    v_perm_b32 v128, v177, v177, v7
    v_perm_b32 v129, v177, v177, v8
    v_perm_b32 v130, v177, v177, v9
    v_perm_b32 v131, v177, v177, v10
    s_waitcnt vmcnt(10)
    s_nop 0
    v_mfma_f32_16x16x32_bf16 v[180:183], v[128:131], v[68:71], v[180:183]
    v_perm_b32 v132, v177, v177, v11
    v_perm_b32 v133, v177, v177, v12
    v_perm_b32 v134, v177, v177, v13
    v_perm_b32 v135, v177, v177, v14
    s_waitcnt vmcnt(9)
    s_nop 0
    v_mfma_f32_16x16x32_bf16 v[180:183], v[132:135], v[72:75], v[180:183]
    v_perm_b32 v128, v178, v178, v7
    v_perm_b32 v129, v178, v178, v8
    v_perm_b32 v130, v178, v178, v9
    v_perm_b32 v131, v178, v178, v10
    s_waitcnt vmcnt(8)
    s_nop 0
    v_mfma_f32_16x16x32_bf16 v[180:183], v[128:131], v[90:93], v[180:183]
    s_lshl_b32 s67, s79, 7
    s_add_u32 s67, s67, 1138688
    s_nop 5
    v_and_or_b32 v180, v180, v5, s63
    v_and_or_b32 v181, v181, v5, s63
    v_and_or_b32 v182, v182, v5, s63
    v_and_or_b32 v183, v183, v5, s63
    buffer_store_dwordx4 v[180:183], v38, s[48:51], s67 offen sc1
    v_lshrrev_b32 v15, 3, v2
    v_lshlrev_b32 v15, 6, v15
    v_lshl_add_u32 v15, v1, 4, v15
    s_lshl_b32 s67, s80, 7
    s_add_u32 s67, s67, 548864
    s_waitcnt vmcnt(1)
    s_barrier
    ds_read_b128 v[160:163], v15 offset:11776
    s_waitcnt lgkmcnt(0)
    v_perm_b32 v128, v160, v160, v7
    v_perm_b32 v129, v160, v160, v8
    v_perm_b32 v130, v160, v160, v9
    v_perm_b32 v131, v160, v160, v10
    s_nop 1
    v_mfma_f32_16x16x32_bf16 v[164:167], v[128:131], v[94:97], 0
    v_perm_b32 v132, v160, v160, v11
    v_perm_b32 v133, v160, v160, v12
    v_perm_b32 v134, v160, v160, v13
    v_perm_b32 v135, v160, v160, v14
    s_nop 1
    v_mfma_f32_16x16x32_bf16 v[164:167], v[132:135], v[98:101], v[164:167]
    v_perm_b32 v128, v161, v161, v7
    v_perm_b32 v129, v161, v161, v8
    v_perm_b32 v130, v161, v161, v9
    v_perm_b32 v131, v161, v161, v10
    s_nop 1
    v_mfma_f32_16x16x32_bf16 v[164:167], v[128:131], v[102:105], v[164:167]
    v_perm_b32 v132, v161, v161, v11
    v_perm_b32 v133, v161, v161, v12
    v_perm_b32 v134, v161, v161, v13
    v_perm_b32 v135, v161, v161, v14
    s_nop 1
    v_mfma_f32_16x16x32_bf16 v[164:167], v[132:135], v[106:109], v[164:167]
    v_perm_b32 v128, v162, v162, v7
    v_perm_b32 v129, v162, v162, v8
    v_perm_b32 v130, v162, v162, v9
    v_perm_b32 v131, v162, v162, v10
    s_nop 1
    v_mfma_f32_16x16x32_bf16 v[164:167], v[128:131], v[110:113], v[164:167]
    v_perm_b32 v132, v162, v162, v11
    v_perm_b32 v133, v162, v162, v12
    v_perm_b32 v134, v162, v162, v13
    v_perm_b32 v135, v162, v162, v14
    s_nop 1
    v_mfma_f32_16x16x32_bf16 v[164:167], v[132:135], v[114:117], v[164:167]
    v_perm_b32 v128, v163, v163, v7
    v_perm_b32 v129, v163, v163, v8
    v_perm_b32 v130, v163, v163, v9
    v_perm_b32 v131, v163, v163, v10
    s_nop 1
    v_mfma_f32_16x16x32_bf16 v[164:167], v[128:131], v[118:121], v[164:167]
    v_perm_b32 v132, v163, v163, v11
    v_perm_b32 v133, v163, v163, v12
    v_perm_b32 v134, v163, v163, v13
    v_perm_b32 v135, v163, v163, v14
    s_nop 1
    v_mfma_f32_16x16x32_bf16 v[164:167], v[132:135], v[122:125], v[164:167]
    s_nop 7
    v_and_or_b32 v164, v164, v5, s63
    v_and_or_b32 v165, v165, v5, s63
    v_and_or_b32 v166, v166, v5, s63
    v_and_or_b32 v167, v167, v5, s63
    buffer_store_dwordx4 v[164:167], v38, s[48:51], s67 offen sc1
    s_branch L_fin
L_comm:
    ds_read_b128 v[156:159], v4 offset:7680
    ds_read_b128 v[160:163], v4 offset:8704
    ds_read_b128 v[164:167], v4 offset:9728
    ds_read_b128 v[168:171], v4 offset:10752
    s_waitcnt lgkmcnt(0)
    v_add_f32 v156, v156, v160
    v_add_f32 v164, v164, v168
    v_add_f32 v157, v157, v161
    v_add_f32 v165, v165, v169
    v_add_f32 v158, v158, v162
    v_add_f32 v166, v166, v170
    v_add_f32 v159, v159, v163
    v_add_f32 v167, v167, v171
    v_add_f32 v156, v156, v164
    v_add_f32 v157, v157, v165
    v_add_f32 v158, v158, v166
    v_add_f32 v159, v159, v167
    v_and_or_b32 v156, v156, v5, s63
    v_and_or_b32 v157, v157, v5, s63
    v_and_or_b32 v158, v158, v5, s63
    v_and_or_b32 v159, v159, v5, s63
    buffer_store_dwordx4 v[156:159], v172, s[48:51], s87 offen sc1
    s_waitcnt vmcnt(1)
L_stchk:
    v_cmp_gt_u32 s[68:69], 16, v0
    v_bitop3_b32 v15, v140, v141, s63 bitop3:0x7e
    v_bitop3_b32 v16, v142, v143, s63 bitop3:0x7e
    v_or_b32 v15, v15, v16
    v_and_b32 v15, 255, v15
    v_cmp_ne_u32 vcc, 0, v15
    s_nop 0
    s_and_b64 s[70:71], vcc, s[68:69]
    s_cbranch_scc0 L_stok
    s_cmp_eq_u32 s72, 0
    s_cbranch_scc1 L_stok
    s_sub_u32 s72, s72, 1
    s_lshl_b32 s67, s76, 8
    s_add_u32 s67, s67, 282624
    buffer_load_dwordx4 v[140:143], v44, s[48:51], s67 offen sc1
    s_waitcnt vmcnt(0)
    s_branch L_stchk
L_stok:
    s_cmp_eq_u32 s75, 0
    s_cbranch_scc1 L_h0
    v_mov_b32 v140, v142
    v_mov_b32 v141, v143
L_h0:
    v_and_b32 v140, v140, v5
    v_and_b32 v141, v141, v5
    v_mov_b32 v142, v140
    s_nop 1
    v_max_f32_dpp v142, v142, v142 quad_perm:[1,0,3,2] row_mask:0xf bank_mask:0xf
    s_nop 1
    v_max_f32_dpp v142, v142, v142 quad_perm:[2,3,0,1] row_mask:0xf bank_mask:0xf
    s_nop 1
    v_max_f32_dpp v142, v142, v142 row_half_mirror row_mask:0xf bank_mask:0xf
    v_sub_f32 v140, v140, v142
    v_mul_f32 v140, s73, v140
    v_exp_f32 v140, v140
    s_nop 0
    v_mul_f32 v141, v141, v140
    s_nop 1
    v_add_f32_dpp v141, v141, v141 quad_perm:[1,0,3,2] row_mask:0xf bank_mask:0xf
    s_nop 1
    v_add_f32_dpp v141, v141, v141 quad_perm:[2,3,0,1] row_mask:0xf bank_mask:0xf
    s_nop 1
    v_add_f32_dpp v141, v141, v141 row_half_mirror row_mask:0xf bank_mask:0xf
    v_rcp_f32 v143, v141
    s_nop 0
    v_mul_f32 v142, v140, v143
    v_fma_f32 v140, -v142, v141, v140
    v_fma_f32 v140, v140, v143, v142
    v_lshlrev_b32 v15, 2, v0
    s_mov_b64 s[70:71], exec
    s_mov_b64 exec, s[68:69]
    ds_write_b32 v15, v140 offset:7296
    s_mov_b64 exec, s[70:71]
    s_waitcnt lgkmcnt(0)
    v_lshrrev_b32 v15, 5, v0
    v_lshlrev_b32 v15, 5, v15
    ds_read_b128 v[144:147], v15 offset:7296
    ds_read_b128 v[148:151], v15 offset:7312
    buffer_load_dword v39, v173, s[48:51], s88 offen offset:0 sc1
    buffer_load_dword v45, v173, s[48:51], s88 offen offset:256 sc1
    buffer_load_dword v46, v173, s[48:51], s88 offen offset:512 sc1
    buffer_load_dword v47, v173, s[48:51], s88 offen offset:768 sc1
    buffer_load_dword v76, v173, s[48:51], s88 offen offset:1024 sc1
    buffer_load_dword v77, v173, s[48:51], s88 offen offset:1280 sc1
    buffer_load_dword v78, v173, s[48:51], s88 offen offset:1536 sc1
    buffer_load_dword v79, v173, s[48:51], s88 offen offset:1792 sc1
    buffer_load_dword v80, v173, s[48:51], s88 offen offset:0 sc1
    buffer_load_dword v81, v173, s[48:51], s88 offen offset:256 sc1
    buffer_load_dword v82, v173, s[48:51], s88 offen offset:512 sc1
    buffer_load_dword v83, v173, s[48:51], s88 offen offset:768 sc1
    buffer_load_dword v84, v173, s[48:51], s88 offen offset:1024 sc1
    buffer_load_dword v85, v173, s[48:51], s88 offen offset:1280 sc1
    buffer_load_dword v86, v173, s[48:51], s88 offen offset:1536 sc1
    buffer_load_dword v87, v173, s[48:51], s88 offen offset:1792 sc1
    buffer_load_dword v88, v173, s[48:51], s88 offen offset:0 sc1
    buffer_load_dword v89, v173, s[48:51], s88 offen offset:256 sc1
    buffer_load_dword v126, v173, s[48:51], s88 offen offset:512 sc1
    buffer_load_dword v127, v173, s[48:51], s88 offen offset:768 sc1
    buffer_load_dword v152, v173, s[48:51], s88 offen offset:1024 sc1
    buffer_load_dword v153, v173, s[48:51], s88 offen offset:1280 sc1
    buffer_load_dword v154, v173, s[48:51], s88 offen offset:1536 sc1
    buffer_load_dword v155, v173, s[48:51], s88 offen offset:1792 sc1
L_opoll:
    s_waitcnt vmcnt(16)
    v_bitop3_b32 v15, v39, v45, s63 bitop3:0x7e
    v_bitop3_b32 v16, v46, v47, s63 bitop3:0x7e
    v_bitop3_b32 v19, v76, v77, s63 bitop3:0x7e
    v_bitop3_b32 v20, v78, v79, s63 bitop3:0x7e
    v_or3_b32 v15, v15, v16, v19
    v_or_b32 v15, v15, v20
    v_and_b32 v15, 255, v15
    v_cmp_ne_u32 vcc, 0, v15
    s_cbranch_vccz L_ook0
    buffer_load_dword v39, v173, s[48:51], s88 offen offset:0 sc1
    buffer_load_dword v45, v173, s[48:51], s88 offen offset:256 sc1
    buffer_load_dword v46, v173, s[48:51], s88 offen offset:512 sc1
    buffer_load_dword v47, v173, s[48:51], s88 offen offset:768 sc1
    buffer_load_dword v76, v173, s[48:51], s88 offen offset:1024 sc1
    buffer_load_dword v77, v173, s[48:51], s88 offen offset:1280 sc1
    buffer_load_dword v78, v173, s[48:51], s88 offen offset:1536 sc1
    buffer_load_dword v79, v173, s[48:51], s88 offen offset:1792 sc1
    s_waitcnt vmcnt(16)
    v_bitop3_b32 v15, v80, v81, s63 bitop3:0x7e
    v_bitop3_b32 v16, v82, v83, s63 bitop3:0x7e
    v_bitop3_b32 v19, v84, v85, s63 bitop3:0x7e
    v_bitop3_b32 v20, v86, v87, s63 bitop3:0x7e
    v_or3_b32 v15, v15, v16, v19
    v_or_b32 v15, v15, v20
    v_and_b32 v15, 255, v15
    v_cmp_ne_u32 vcc, 0, v15
    s_cbranch_vccz L_ook1
    buffer_load_dword v80, v173, s[48:51], s88 offen offset:0 sc1
    buffer_load_dword v81, v173, s[48:51], s88 offen offset:256 sc1
    buffer_load_dword v82, v173, s[48:51], s88 offen offset:512 sc1
    buffer_load_dword v83, v173, s[48:51], s88 offen offset:768 sc1
    buffer_load_dword v84, v173, s[48:51], s88 offen offset:1024 sc1
    buffer_load_dword v85, v173, s[48:51], s88 offen offset:1280 sc1
    buffer_load_dword v86, v173, s[48:51], s88 offen offset:1536 sc1
    buffer_load_dword v87, v173, s[48:51], s88 offen offset:1792 sc1
    s_waitcnt vmcnt(16)
    v_bitop3_b32 v15, v88, v89, s63 bitop3:0x7e
    v_bitop3_b32 v16, v126, v127, s63 bitop3:0x7e
    v_bitop3_b32 v19, v152, v153, s63 bitop3:0x7e
    v_bitop3_b32 v20, v154, v155, s63 bitop3:0x7e
    v_or3_b32 v15, v15, v16, v19
    v_or_b32 v15, v15, v20
    v_and_b32 v15, 255, v15
    v_cmp_ne_u32 vcc, 0, v15
    s_cbranch_vccz L_ook2
    buffer_load_dword v88, v173, s[48:51], s88 offen offset:0 sc1
    buffer_load_dword v89, v173, s[48:51], s88 offen offset:256 sc1
    buffer_load_dword v126, v173, s[48:51], s88 offen offset:512 sc1
    buffer_load_dword v127, v173, s[48:51], s88 offen offset:768 sc1
    buffer_load_dword v152, v173, s[48:51], s88 offen offset:1024 sc1
    buffer_load_dword v153, v173, s[48:51], s88 offen offset:1280 sc1
    buffer_load_dword v154, v173, s[48:51], s88 offen offset:1536 sc1
    buffer_load_dword v155, v173, s[48:51], s88 offen offset:1792 sc1
    s_cmp_eq_u32 s72, 0
    s_cbranch_scc1 L_ook0
    s_sub_u32 s72, s72, 1
    s_branch L_opoll
L_ook0:
    s_waitcnt lgkmcnt(0)
    v_and_b32 v39, v39, v5
    v_and_b32 v45, v45, v5
    v_and_b32 v46, v46, v5
    v_and_b32 v47, v47, v5
    v_and_b32 v76, v76, v5
    v_and_b32 v77, v77, v5
    v_and_b32 v78, v78, v5
    v_and_b32 v79, v79, v5
    v_mul_f32 v15, v39, v144
    v_mul_f32 v16, v45, v145
    v_fmac_f32 v15, v46, v146
    v_fmac_f32 v16, v47, v147
    v_fmac_f32 v15, v76, v148
    v_fmac_f32 v16, v77, v149
    v_fmac_f32 v15, v78, v150
    v_fmac_f32 v16, v79, v151
    s_branch L_ocmb
L_ook1:
    s_waitcnt lgkmcnt(0)
    v_and_b32 v80, v80, v5
    v_and_b32 v81, v81, v5
    v_and_b32 v82, v82, v5
    v_and_b32 v83, v83, v5
    v_and_b32 v84, v84, v5
    v_and_b32 v85, v85, v5
    v_and_b32 v86, v86, v5
    v_and_b32 v87, v87, v5
    v_mul_f32 v15, v80, v144
    v_mul_f32 v16, v81, v145
    v_fmac_f32 v15, v82, v146
    v_fmac_f32 v16, v83, v147
    v_fmac_f32 v15, v84, v148
    v_fmac_f32 v16, v85, v149
    v_fmac_f32 v15, v86, v150
    v_fmac_f32 v16, v87, v151
    s_branch L_ocmb
L_ook2:
    s_waitcnt lgkmcnt(0)
    v_and_b32 v88, v88, v5
    v_and_b32 v89, v89, v5
    v_and_b32 v126, v126, v5
    v_and_b32 v127, v127, v5
    v_and_b32 v152, v152, v5
    v_and_b32 v153, v153, v5
    v_and_b32 v154, v154, v5
    v_and_b32 v155, v155, v5
    v_mul_f32 v15, v88, v144
    v_mul_f32 v16, v89, v145
    v_fmac_f32 v15, v126, v146
    v_fmac_f32 v16, v127, v147
    v_fmac_f32 v15, v152, v148
    v_fmac_f32 v16, v153, v149
    v_fmac_f32 v15, v154, v150
    v_fmac_f32 v16, v155, v151
L_ocmb:
    v_add_f32 v15, v15, v16
    v_lshlrev_b32 v16, 1, v0
    v_cvt_pk_bf16_f32 v15, v15, v15
    ds_write_b16 v16, v15 offset:11776
    s_waitcnt lgkmcnt(0)
    s_barrier
L_fin:
    s_cmp_ge_u32 s89, 36
    s_cbranch_scc1 L_done
    s_lshl_b32 s67, s89, 14
    s_lshl_b32 s68, s3, 12
    s_add_u32 s67, s67, s68
    s_add_u32 s68, s67, 1138688
    s_add_u32 s69, s67, 548864
    buffer_load_dwordx4 v[40:43], v4, s[48:51], s68 offen offset:0 sc1
    buffer_load_dwordx4 v[48:51], v4, s[48:51], s68 offen offset:1024 sc1
    buffer_load_dwordx4 v[52:55], v4, s[48:51], s68 offen offset:2048 sc1
    buffer_load_dwordx4 v[56:59], v4, s[48:51], s68 offen offset:3072 sc1
    buffer_load_dwordx4 v[60:63], v4, s[48:51], s69 offen offset:0 sc1
    buffer_load_dwordx4 v[64:67], v4, s[48:51], s69 offen offset:1024 sc1
    buffer_load_dwordx4 v[68:71], v4, s[48:51], s69 offen offset:2048 sc1
    buffer_load_dwordx4 v[72:75], v4, s[48:51], s69 offen offset:3072 sc1
    v_and_b32 v185, 3, v0
    v_bfe_u32 v186, v0, 2, 1
    v_lshlrev_b32 v185, 3, v185
    v_lshl_add_u32 v185, v186, 2, v185
    v_add_u32 v185, v185, v1
    s_lshl_b32 s67, s3, 2
    v_lshl_add_u32 v185, v185, 4, s67
    v_and_b32 v186, 31, v0
    v_lshlrev_b32 v186, 4, v186
    s_waitcnt vmcnt(4)
    buffer_load_dwordx4 v[94:97], v4, s[48:51], s69 offen offset:0 sc1
    buffer_load_dwordx4 v[98:101], v4, s[48:51], s69 offen offset:1024 sc1
    buffer_load_dwordx4 v[102:105], v4, s[48:51], s69 offen offset:2048 sc1
    buffer_load_dwordx4 v[106:109], v4, s[48:51], s69 offen offset:3072 sc1
L_gchk:
    v_bitop3_b32 v15, v40, v41, s63 bitop3:0x7e
    v_bitop3_b32 v16, v48, v49, s63 bitop3:0x7e
    v_bitop3_b32 v19, v52, v53, s63 bitop3:0x7e
    v_bitop3_b32 v20, v56, v57, s63 bitop3:0x7e
    v_or3_b32 v15, v15, v16, v19
    v_bitop3_b32 v16, v42, v43, s63 bitop3:0x7e
    v_bitop3_b32 v19, v50, v51, s63 bitop3:0x7e
    v_or3_b32 v15, v15, v16, v19
    v_bitop3_b32 v16, v54, v55, s63 bitop3:0x7e
    v_bitop3_b32 v19, v58, v59, s63 bitop3:0x7e
    v_or3_b32 v15, v15, v16, v19
    v_or_b32 v15, v15, v20
    v_and_b32 v15, 255, v15
    v_cmp_ne_u32 vcc, 0, v15
    s_cbranch_vccz L_gok
    s_cmp_eq_u32 s72, 0
    s_cbranch_scc1 L_gok
    s_sub_u32 s72, s72, 1
    buffer_load_dwordx4 v[40:43], v4, s[48:51], s68 offen offset:0 sc1
    buffer_load_dwordx4 v[48:51], v4, s[48:51], s68 offen offset:1024 sc1
    buffer_load_dwordx4 v[52:55], v4, s[48:51], s68 offen offset:2048 sc1
    buffer_load_dwordx4 v[56:59], v4, s[48:51], s68 offen offset:3072 sc1
    s_waitcnt vmcnt(0)
    s_branch L_gchk
L_gok:
    v_and_b32 v40, v40, v5
    v_and_b32 v41, v41, v5
    v_and_b32 v42, v42, v5
    v_and_b32 v43, v43, v5
    v_and_b32 v48, v48, v5
    v_and_b32 v49, v49, v5
    v_and_b32 v50, v50, v5
    v_and_b32 v51, v51, v5
    v_and_b32 v52, v52, v5
    v_and_b32 v53, v53, v5
    v_and_b32 v54, v54, v5
    v_and_b32 v55, v55, v5
    v_and_b32 v56, v56, v5
    v_and_b32 v57, v57, v5
    v_and_b32 v58, v58, v5
    v_and_b32 v59, v59, v5
    v_add_f32 v40, v40, v48
    v_add_f32 v41, v41, v49
    v_add_f32 v42, v42, v50
    v_add_f32 v43, v43, v51
    v_add_f32 v52, v52, v56
    v_add_f32 v53, v53, v57
    v_add_f32 v54, v54, v58
    v_add_f32 v55, v55, v59
    v_add_f32 v40, v40, v52
    v_add_f32 v41, v41, v53
    v_add_f32 v42, v42, v54
    v_add_f32 v43, v43, v55
    v_add_f32_dpp v40, v40, v40 row_ror:8 row_mask:0xf bank_mask:0xf
    v_add_f32_dpp v41, v41, v41 row_ror:8 row_mask:0xf bank_mask:0xf
    v_add_f32_dpp v42, v42, v42 row_ror:8 row_mask:0xf bank_mask:0xf
    v_add_f32_dpp v43, v43, v43 row_ror:8 row_mask:0xf bank_mask:0xf
    v_permlane16_swap_b32 v40, v41
    s_nop 0
    v_permlane16_swap_b32 v42, v43
    v_add_f32 v40, v40, v41
    v_add_f32 v42, v42, v43
    s_nop 1
    v_permlane32_swap_b32 v40, v42
    v_add_f32 v118, v40, v42
    ds_write_b32 v185, v118 offset:11904
    s_waitcnt lgkmcnt(0)
    s_barrier
    ds_read_b128 v[110:113], v186 offset:11904
    s_waitcnt lgkmcnt(0)
    v_add_f32 v110, v110, v111
    v_add_f32 v112, v112, v113
    v_add_f32 v110, v110, v112
    v_cvt_pk_bf16_f32 v110, 0, v110
    v_mul_f32 v111, s73, v110
    v_exp_f32 v111, -v111
    s_nop 0
    v_add_f32 v111, 1.0, v111
    v_rcp_f32 v111, v111
    s_nop 0
    v_mul_f32 v110, v110, v111
    v_cvt_pk_bf16_f32 v110, 0, v110
    v_lshlrev_b32 v34, 16, v34
L_schk:
    s_waitcnt vmcnt(4)
    v_bitop3_b32 v15, v60, v61, s63 bitop3:0x7e
    v_bitop3_b32 v16, v64, v65, s63 bitop3:0x7e
    v_bitop3_b32 v19, v68, v69, s63 bitop3:0x7e
    v_bitop3_b32 v20, v72, v73, s63 bitop3:0x7e
    v_or3_b32 v15, v15, v16, v19
    v_bitop3_b32 v16, v62, v63, s63 bitop3:0x7e
    v_bitop3_b32 v19, v66, v67, s63 bitop3:0x7e
    v_or3_b32 v15, v15, v16, v19
    v_bitop3_b32 v16, v70, v71, s63 bitop3:0x7e
    v_bitop3_b32 v19, v74, v75, s63 bitop3:0x7e
    v_or3_b32 v15, v15, v16, v19
    v_or_b32 v15, v15, v20
    v_and_b32 v15, 255, v15
    v_cmp_ne_u32 vcc, 0, v15
    s_cbranch_vccz L_sok0
    buffer_load_dwordx4 v[60:63], v4, s[48:51], s69 offen offset:0 sc1
    buffer_load_dwordx4 v[64:67], v4, s[48:51], s69 offen offset:1024 sc1
    buffer_load_dwordx4 v[68:71], v4, s[48:51], s69 offen offset:2048 sc1
    buffer_load_dwordx4 v[72:75], v4, s[48:51], s69 offen offset:3072 sc1
    s_waitcnt vmcnt(4)
    v_bitop3_b32 v15, v94, v95, s63 bitop3:0x7e
    v_bitop3_b32 v16, v98, v99, s63 bitop3:0x7e
    v_bitop3_b32 v19, v102, v103, s63 bitop3:0x7e
    v_bitop3_b32 v20, v106, v107, s63 bitop3:0x7e
    v_or3_b32 v15, v15, v16, v19
    v_bitop3_b32 v16, v96, v97, s63 bitop3:0x7e
    v_bitop3_b32 v19, v100, v101, s63 bitop3:0x7e
    v_or3_b32 v15, v15, v16, v19
    v_bitop3_b32 v16, v104, v105, s63 bitop3:0x7e
    v_bitop3_b32 v19, v108, v109, s63 bitop3:0x7e
    v_or3_b32 v15, v15, v16, v19
    v_or_b32 v15, v15, v20
    v_and_b32 v15, 255, v15
    v_cmp_ne_u32 vcc, 0, v15
    s_cbranch_vccz L_sok1
    buffer_load_dwordx4 v[94:97], v4, s[48:51], s69 offen offset:0 sc1
    buffer_load_dwordx4 v[98:101], v4, s[48:51], s69 offen offset:1024 sc1
    buffer_load_dwordx4 v[102:105], v4, s[48:51], s69 offen offset:2048 sc1
    buffer_load_dwordx4 v[106:109], v4, s[48:51], s69 offen offset:3072 sc1
    s_cmp_eq_u32 s72, 0
    s_cbranch_scc1 L_sok0
    s_sub_u32 s72, s72, 1
    s_branch L_schk
L_sok0:
    v_and_b32 v60, v60, v5
    v_and_b32 v61, v61, v5
    v_and_b32 v62, v62, v5
    v_and_b32 v63, v63, v5
    v_and_b32 v64, v64, v5
    v_and_b32 v65, v65, v5
    v_and_b32 v66, v66, v5
    v_and_b32 v67, v67, v5
    v_and_b32 v68, v68, v5
    v_and_b32 v69, v69, v5
    v_and_b32 v70, v70, v5
    v_and_b32 v71, v71, v5
    v_and_b32 v72, v72, v5
    v_and_b32 v73, v73, v5
    v_and_b32 v74, v74, v5
    v_and_b32 v75, v75, v5
    v_add_f32 v60, v60, v64
    v_add_f32 v61, v61, v65
    v_add_f32 v62, v62, v66
    v_add_f32 v63, v63, v67
    v_add_f32 v68, v68, v72
    v_add_f32 v69, v69, v73
    v_add_f32 v70, v70, v74
    v_add_f32 v71, v71, v75
    v_add_f32 v60, v60, v68
    v_add_f32 v61, v61, v69
    v_add_f32 v62, v62, v70
    v_add_f32 v63, v63, v71
    v_add_f32_dpp v60, v60, v60 row_ror:8 row_mask:0xf bank_mask:0xf
    v_add_f32_dpp v61, v61, v61 row_ror:8 row_mask:0xf bank_mask:0xf
    v_add_f32_dpp v62, v62, v62 row_ror:8 row_mask:0xf bank_mask:0xf
    v_add_f32_dpp v63, v63, v63 row_ror:8 row_mask:0xf bank_mask:0xf
    v_permlane16_swap_b32 v60, v61
    s_nop 0
    v_permlane16_swap_b32 v62, v63
    v_add_f32 v60, v60, v61
    v_add_f32 v62, v62, v63
    s_nop 1
    v_permlane32_swap_b32 v60, v62
    v_add_f32 v118, v60, v62
    s_branch L_sred
L_sok1:
    v_and_b32 v94, v94, v5
    v_and_b32 v95, v95, v5
    v_and_b32 v96, v96, v5
    v_and_b32 v97, v97, v5
    v_and_b32 v98, v98, v5
    v_and_b32 v99, v99, v5
    v_and_b32 v100, v100, v5
    v_and_b32 v101, v101, v5
    v_and_b32 v102, v102, v5
    v_and_b32 v103, v103, v5
    v_and_b32 v104, v104, v5
    v_and_b32 v105, v105, v5
    v_and_b32 v106, v106, v5
    v_and_b32 v107, v107, v5
    v_and_b32 v108, v108, v5
    v_and_b32 v109, v109, v5
    v_add_f32 v94, v94, v98
    v_add_f32 v95, v95, v99
    v_add_f32 v96, v96, v100
    v_add_f32 v97, v97, v101
    v_add_f32 v102, v102, v106
    v_add_f32 v103, v103, v107
    v_add_f32 v104, v104, v108
    v_add_f32 v105, v105, v109
    v_add_f32 v94, v94, v102
    v_add_f32 v95, v95, v103
    v_add_f32 v96, v96, v104
    v_add_f32 v97, v97, v105
    v_add_f32_dpp v94, v94, v94 row_ror:8 row_mask:0xf bank_mask:0xf
    v_add_f32_dpp v95, v95, v95 row_ror:8 row_mask:0xf bank_mask:0xf
    v_add_f32_dpp v96, v96, v96 row_ror:8 row_mask:0xf bank_mask:0xf
    v_add_f32_dpp v97, v97, v97 row_ror:8 row_mask:0xf bank_mask:0xf
    v_permlane16_swap_b32 v94, v95
    s_nop 0
    v_permlane16_swap_b32 v96, v97
    v_add_f32 v94, v94, v95
    v_add_f32 v96, v96, v97
    s_nop 1
    v_permlane32_swap_b32 v94, v96
    v_add_f32 v118, v94, v96
L_sred:
    ds_write_b32 v185, v118 offset:12416
    s_waitcnt lgkmcnt(0)
    s_barrier
    s_cmp_eq_u32 s3, 0
    s_cbranch_scc1 L_fin0
    s_cmp_lg_u32 s3, 1
    s_cbranch_scc1 L_done
    s_cmp_lg_u32 s89, 0
    s_cbranch_scc1 L_done
    v_cmp_eq_u32 vcc, 0, v0
    v_mov_b32 v16, 2146435072
    s_nop 0
    v_cndmask_b32 v16, v16, 0, vcc
    v_mov_b32 v15, s62
    buffer_store_dword v15, v16, s[48:51], 0 offen
    s_branch L_done
L_fin0:
    ds_read_b128 v[114:117], v186 offset:12416
    s_waitcnt lgkmcnt(0)
    v_add_f32 v114, v114, v115
    v_add_f32 v116, v116, v117
    v_add_f32 v114, v114, v116
    v_cvt_pk_bf16_f32 v114, 0, v114
    v_mul_f32 v114, v114, v110
    v_cvt_pk_bf16_f32 v114, 0, v114
    v_add_f32 v114, v114, v34
    v_cvt_pk_bf16_f32 v114, v114, v114
    buffer_store_short v114, v35, s[56:59], 0 offen
L_done:
    s_waitcnt vmcnt(0)
L_end:
    s_endpgm
L_codelast:
    s_nop 0
    s_nop 0
    s_nop 0
    s_nop 0
.section .rodata,"a"
.p2align 6
.amdhsa_kernel recurrent_scan__sliding_block_cached__glu_gated_swiglu__decode_kernel
  .amdhsa_next_free_vgpr 512
  .amdhsa_next_free_sgpr 102
  .amdhsa_accum_offset 256
  .amdhsa_group_segment_fixed_size 0
  .amdhsa_kernarg_size 96
  .amdhsa_user_sgpr_count 2
  .amdhsa_user_sgpr_kernarg_segment_ptr 1
  .amdhsa_system_sgpr_workgroup_id_x 1
  .amdhsa_float_denorm_mode_32 3
.end_amdhsa_kernel
```
